```python
import torch

def _softmax(x, axis=-1):
    return torch.softmax(x, dim=axis)
def _gelu(x):
    return torch.nn.functional.gelu(x, approximate="tanh")
def _silu(x):
    return torch.nn.functional.silu(x)
def _sigmoid(x):
    return torch.sigmoid(x)
def _layernorm(x, axis=-1, eps=1e-5):
    m = x.mean(dim=axis, keepdim=True)
    v = x.var(dim=axis, keepdim=True, unbiased=False)
    return (x - m) / torch.sqrt(v + eps)
def _scatter_add(tgt, idx, src, axis=0):
    return tgt.clone().index_add_(axis, idx, src)
def _segment_sum(src, seg, n):
    out = torch.zeros((n,) + src.shape[1:], dtype=src.dtype)
    return out.index_add_(0, seg, src)
def _pad(x, pw):
    flat = tuple(v for pair in reversed(pw) for v in pair)
    return torch.nn.functional.pad(x, flat)

kernel_name = 'gated_mix__sliding_local_dilated__sliding_local_dilated__prompt'

def setup_inputs():

    _w = (lambda a: (lambda t: t.to(torch.bfloat16) if t.is_floating_point() else t)(torch.as_tensor(a)))
    def _A_setup():
        B, S, D = 1, 2048, 576
        return {
            "x": _w((lambda *s: torch.randn(*s, dtype=torch.bfloat16) * 0.05)(B, S, D)),
            "wqkv": _w((lambda *s: torch.randn(*s, dtype=torch.bfloat16) * 0.8)(D, 3 * D)),
            "wo": _w((lambda *s: torch.randn(*s, dtype=torch.bfloat16) * 0.05)(D, D)),
        }
    _A_in = _A_setup()

    def _B_setup():
        B, S, D = 1, 2048, 576
        return {
            "x": _w((lambda *s: torch.randn(*s, dtype=torch.bfloat16) * 0.05)(B, S, D)),
            "wqkv": _w((lambda *s: torch.randn(*s, dtype=torch.bfloat16) * 0.8)(D, 3 * D)),
            "wo": _w((lambda *s: torch.randn(*s, dtype=torch.bfloat16) * 0.05)(D, D)),
        }
    _B_in = _B_setup()

    return {
        "A_x": _A_in["x"],
        "A_wqkv": _A_in["wqkv"],
        "A_wo": _A_in["wo"],
        "B_x": _B_in["x"],
        "B_wqkv": _B_in["wqkv"],
        "B_wo": _B_in["wo"],
        "gate_w": _w((lambda *s: torch.randn(*s, dtype=torch.bfloat16) * 0.05)(576) * 16.0),
    }

def reference(A_x, A_wqkv, A_wo, B_x, B_wqkv, B_wo, gate_w):
    def _A_ref(x, wqkv, wo):
        B, S, D = x.shape
        H = 32; Dh = D // H
        W, dil = 8, 2
        qkv = (lambda x, *d: x.permute(*d))((x @ wqkv).reshape(B, S, 3, H, Dh), 2, 0, 3, 1, 4)
        q, k, v = qkv[0], qkv[1], qkv[2]
        scale = Dh ** -0.5
        pos = torch.arange(S)
        off = torch.arange(W) * dil
        idx = pos[:, None] - off[None, :]
        mask = idx >= 0
        idx_c = torch.where(mask, idx, 0).reshape(-1)
        kg = k[:, :, idx_c, :].reshape(B, H, S, W, Dh)
        vg = v[:, :, idx_c, :].reshape(B, H, S, W, Dh)
        logits = torch.einsum("bhsd,bhswd->bhsw", q, kg) * scale
        logits = torch.where(mask[None, None, :, :], logits, -1e9)
        attn = _softmax(logits, axis=-1)
        o = torch.einsum("bhsw,bhswd->bhsd", attn, vg)
        return (lambda x, *d: x.permute(*d))(o, 0, 2, 1, 3).reshape(B, S, D) @ wo

    def _B_ref(x, wqkv, wo):
        B, S, D = x.shape
        H = 32; Dh = D // H
        W, dil = 8, 2
        qkv = (lambda x, *d: x.permute(*d))((x @ wqkv).reshape(B, S, 3, H, Dh), 2, 0, 3, 1, 4)
        q, k, v = qkv[0], qkv[1], qkv[2]
        scale = Dh ** -0.5
        pos = torch.arange(S)
        off = torch.arange(W) * dil
        idx = pos[:, None] - off[None, :]
        mask = idx >= 0
        idx_c = torch.where(mask, idx, 0).reshape(-1)
        kg = k[:, :, idx_c, :].reshape(B, H, S, W, Dh)
        vg = v[:, :, idx_c, :].reshape(B, H, S, W, Dh)
        logits = torch.einsum("bhsd,bhswd->bhsw", q, kg) * scale
        logits = torch.where(mask[None, None, :, :], logits, -1e9)
        attn = _softmax(logits, axis=-1)
        o = torch.einsum("bhsw,bhswd->bhsd", attn, vg)
        return (lambda x, *d: x.permute(*d))(o, 0, 2, 1, 3).reshape(B, S, D) @ wo

    x = A_x
    g = _sigmoid((x * gate_w).sum(-1, keepdims=True))
    a = _A_ref(x, A_wqkv, A_wo)
    b = _B_ref(x, B_wqkv, B_wo)
    return g * a + (1 - g) * b
```

```asm
; @launch grid=(256,1,1) block=(256,1,1) lds=163840
.amdgcn_target "amdgcn-amd-amdhsa--gfx950"
.text
.globl gated_mix__sliding_local_dilated__sliding_local_dilated__prompt_kernel
.p2align 12
.type gated_mix__sliding_local_dilated__sliding_local_dilated__prompt_kernel,@function
gated_mix__sliding_local_dilated__sliding_local_dilated__prompt_kernel:
    s_cmp_ge_u32 s2, 256
    s_cbranch_scc1 .Lend
    s_load_dwordx16 s[16:31], s[0:1], 0
    s_load_dwordx4 s[32:35], s[0:1], 64
    v_lshrrev_b32 v2, 6, v0
    v_and_b32 v1, 63, v0
    v_readfirstlane_b32 s3, v2
    s_and_b32 s4, s2, 7
    s_lshr_b32 s5, s2, 3
    s_lshl_b32 s72, s4, 1
    s_and_b32 s73, s5, 1
    s_add_u32 s6, s72, s73
    s_lshr_b32 s7, s5, 1
    s_mul_i32 s11, s7, 1
    s_mul_i32 s72, s4, 1
    s_add_u32 s11, s11, s72
    s_mul_i32 s72, s11, 57
    s_lshr_b32 s72, s72, 9
    s_mul_i32 s72, s72, 9
    s_sub_u32 s11, s11, s72
    s_mov_b32 s14, s11
    s_lshr_b32 s8, s7, 3
    s_and_b32 s9, s7, 7
    v_lshrrev_b32 v3, 3, v1
    v_and_b32 v4, 7, v1
    v_xor_b32 v4, v4, v3
    v_mul_u32_u24 v5, 2304, v3
    v_lshl_add_u32 v5, v4, 4, v5
    s_lshl_b32 s72, s6, 7
    s_lshl_b32 s73, s3, 4
    s_add_u32 s73, s73, s72
    s_mul_i32 s73, s73, 1152
    v_add_u32 v10, s73, v5
    v_add_u32 v11, 73728, v10
    v_add_u32 v12, 1152, v10
    v_add_u32 v13, 1152, v11
    s_lshl_b32 s67, s3, 10
    s_lshl_b32 s64, s11, 7
    s_mul_i32 s65, s11, 221184
    s_mul_i32 s75, s9, 144
    s_lshl_b32 s72, s4, 10
    s_add_u32 s72, s72, 4726784
    v_lshlrev_b32 v89, 4, v1
    v_add_u32 v89, s72, v89
    s_or_b32 s76, s5, s3
    v_mul_u32_u24 v6, 607, v0
    v_lshrrev_b32 v6, 14, v6
    v_mul_u32_u24 v7, 27, v6
    v_sub_u32 v7, v0, v7
    v_mul_u32_u24 v8, 57, v7
    v_lshrrev_b32 v8, 9, v8
    v_bfe_u32 v9, v6, 1, 2
    v_and_or_b32 v9, v6, 56, v9
    v_and_b32 v6, 1, v6
    v_lshl_or_b32 v9, v6, 2, v9
    v_mul_u32_u24 v9, 3456, v9
    v_lshl_add_u32 v9, v7, 4, v9
    v_mul_u32_u24 v8, 1008, v8
    v_add3_u32 v14, v9, v8, s75
    v_add_u32 v2, 256, v0
    v_mul_u32_u24 v6, 607, v2
    v_lshrrev_b32 v6, 14, v6
    v_mul_u32_u24 v7, 27, v6
    v_sub_u32 v7, v2, v7
    v_mul_u32_u24 v8, 57, v7
    v_lshrrev_b32 v8, 9, v8
    v_bfe_u32 v9, v6, 1, 2
    v_and_or_b32 v9, v6, 56, v9
    v_and_b32 v6, 1, v6
    v_lshl_or_b32 v9, v6, 2, v9
    v_mul_u32_u24 v9, 3456, v9
    v_lshl_add_u32 v9, v7, 4, v9
    v_mul_u32_u24 v8, 1008, v8
    v_add3_u32 v15, v9, v8, s75
    s_waitcnt lgkmcnt(0)
    s_mov_b32 s36, s16
    s_and_b32 s37, s17, 0xffff
    s_mov_b32 s38, 2359296
    s_mov_b32 s39, 0x20000
    s_cmp_eq_u32 s76, 0
    s_cbranch_scc0 .nolead_1
    v_mov_b32 v220, 0
    v_mov_b32 v221, 0
    v_mov_b32 v222, 0
    v_mov_b32 v223, 0
    global_store_dwordx4 v89, v[220:223], s[34:35]
.nolead_1:
    s_cmp_eq_u32 s8, 1
    s_cselect_b32 s40, s24, s18
    s_cselect_b32 s41, s25, s19
    s_and_b32 s41, s41, 0xffff
    s_mov_b32 s42, 1990656
    s_mov_b32 s43, 0x20000
    s_add_u32 m0, s67, 0
    s_nop 0
    buffer_load_dwordx4 v10, s[36:39], s64 offen lds
    s_add_u32 m0, s67, 4096
    s_nop 0
    buffer_load_dwordx4 v11, s[36:39], s64 offen lds
    s_add_u32 m0, s67, 8192
    s_nop 0
    buffer_load_dwordx4 v12, s[36:39], s64 offen lds
    s_add_u32 m0, s67, 12288
    s_nop 0
    buffer_load_dwordx4 v13, s[36:39], s64 offen lds
    s_add_u32 m0, s67, 55296
    s_nop 0
    buffer_load_dwordx4 v14, s[40:43], s65 offen lds
    s_add_u32 m0, s67, 59392
    s_nop 0
    buffer_load_dwordx4 v15, s[40:43], s65 offen lds
    s_cmp_eq_u32 s3, 3
    s_cbranch_scc0 .nocpf_2
    s_getpc_b64 s[78:79]
.Lpc:
    s_mul_i32 s72, s5, 86
    s_lshr_b32 s72, s72, 8
    s_mul_i32 s72, s72, 3
    s_sub_u32 s72, s5, s72
    s_lshl_b32 s72, s72, 13
    v_lshlrev_b32 v2, 7, v1
    v_add_u32 v2, s72, v2
    v_min_u32 v2, .Lend-.Lpc, v2
    global_load_dword v255, v2, s[78:79]
.nocpf_2:
    s_cmp_eq_u32 s7, 0
    s_cbranch_scc0 .nogate_3
    v_lshlrev_b32 v2, 2, v0
    v_add_u32 v3, 256, v0
    v_min_u32 v3, 287, v3
    v_lshlrev_b32 v3, 2, v3
    global_load_dword v30, v2, s[28:29]
    global_load_dword v90, v3, s[28:29]
.nogate_3:
    v_add_u32 v2, 512, v0
    s_add_u32 m0, s67, 63488
    v_mul_u32_u24 v6, 607, v2
    v_lshrrev_b32 v6, 14, v6
    v_mul_u32_u24 v7, 27, v6
    v_sub_u32 v7, v2, v7
    v_mul_u32_u24 v8, 57, v7
    v_lshrrev_b32 v8, 9, v8
    v_bfe_u32 v9, v6, 1, 2
    v_and_or_b32 v9, v6, 56, v9
    v_and_b32 v6, 1, v6
    v_lshl_or_b32 v9, v6, 2, v9
    v_mul_u32_u24 v9, 3456, v9
    v_lshl_add_u32 v9, v7, 4, v9
    v_mul_u32_u24 v8, 1008, v8
    v_add3_u32 v16, v9, v8, s75
    buffer_load_dwordx4 v16, s[40:43], s65 offen lds
    v_add_u32 v2, 768, v0
    s_add_u32 m0, s67, 67584
    v_mul_u32_u24 v6, 607, v2
    v_lshrrev_b32 v6, 14, v6
    v_mul_u32_u24 v7, 27, v6
    v_sub_u32 v7, v2, v7
    v_mul_u32_u24 v8, 57, v7
    v_lshrrev_b32 v8, 9, v8
    v_bfe_u32 v9, v6, 1, 2
    v_and_or_b32 v9, v6, 56, v9
    v_and_b32 v6, 1, v6
    v_lshl_or_b32 v9, v6, 2, v9
    v_mul_u32_u24 v9, 3456, v9
    v_lshl_add_u32 v9, v7, 4, v9
    v_mul_u32_u24 v8, 1008, v8
    v_add3_u32 v17, v9, v8, s75
    buffer_load_dwordx4 v17, s[40:43], s65 offen lds
    v_add_u32 v2, 1024, v0
    s_add_u32 m0, s67, 71680
    v_mul_u32_u24 v6, 607, v2
    v_lshrrev_b32 v6, 14, v6
    v_mul_u32_u24 v7, 27, v6
    v_sub_u32 v7, v2, v7
    v_mul_u32_u24 v8, 57, v7
    v_lshrrev_b32 v8, 9, v8
    v_bfe_u32 v9, v6, 1, 2
    v_and_or_b32 v9, v6, 56, v9
    v_and_b32 v6, 1, v6
    v_lshl_or_b32 v9, v6, 2, v9
    v_mul_u32_u24 v9, 3456, v9
    v_lshl_add_u32 v9, v7, 4, v9
    v_mul_u32_u24 v8, 1008, v8
    v_add3_u32 v18, v9, v8, s75
    buffer_load_dwordx4 v18, s[40:43], s65 offen lds
    v_add_u32 v2, 1280, v0
    s_add_u32 m0, s67, 75776
    v_mul_u32_u24 v6, 607, v2
    v_lshrrev_b32 v6, 14, v6
    v_mul_u32_u24 v7, 27, v6
    v_sub_u32 v7, v2, v7
    v_mul_u32_u24 v8, 57, v7
    v_lshrrev_b32 v8, 9, v8
    v_bfe_u32 v9, v6, 1, 2
    v_and_or_b32 v9, v6, 56, v9
    v_and_b32 v6, 1, v6
    v_lshl_or_b32 v9, v6, 2, v9
    v_mul_u32_u24 v9, 3456, v9
    v_lshl_add_u32 v9, v7, 4, v9
    v_mul_u32_u24 v8, 1008, v8
    v_add3_u32 v19, v9, v8, s75
    buffer_load_dwordx4 v19, s[40:43], s65 offen lds
    v_add_u32 v2, 1408, v0
    v_mul_u32_u24 v6, 607, v2
    v_lshrrev_b32 v6, 14, v6
    v_mul_u32_u24 v7, 27, v6
    v_sub_u32 v7, v2, v7
    v_mul_u32_u24 v8, 57, v7
    v_lshrrev_b32 v8, 9, v8
    v_bfe_u32 v9, v6, 1, 2
    v_and_or_b32 v9, v6, 56, v9
    v_and_b32 v6, 1, v6
    v_lshl_or_b32 v9, v6, 2, v9
    v_mul_u32_u24 v9, 3456, v9
    v_lshl_add_u32 v9, v7, 4, v9
    v_mul_u32_u24 v8, 1008, v8
    v_add3_u32 v20, v9, v8, s75
    s_lshl_b32 s72, s6, 7
    s_sub_u32 s72, s72, 16
    s_max_i32 s72, s72, 0
    s_add_u32 s72, s72, s3
    s_mul_i32 s72, s72, 1152
    v_add_u32 v5, s72, v5
    s_cmp_lt_u32 s3, 2
    s_cselect_b64 vcc, -1, 0
    s_cselect_b32 s44, s36, s40
    s_cselect_b32 s45, s37, s41
    s_cselect_b32 s46, s38, s42
    s_mov_b32 s47, 0x20000
    s_cselect_b32 s66, s64, s65
    s_mov_b32 s72, 77824
    s_cselect_b32 s72, 16384, s72
    s_add_u32 s68, s72, s67
    s_movk_i32 s72, 27648
    s_mov_b32 m0, s68
    v_cndmask_b32 v20, v20, v5, vcc
    buffer_load_dwordx4 v20, s[44:47], s66 offen lds
    s_cmp_lt_u32 s3, 2
    s_cselect_b32 s72, 18432, s72
    s_add_u32 s69, s68, s72
    s_add_u32 s70, s69, s72
    s_lshl_b32 s71, s3, 8
    v_lshrrev_b32 v2, 2, v0
    v_add_u32 v2, 1664, v2
    v_mul_u32_u24 v6, 607, v2
    v_lshrrev_b32 v6, 14, v6
    v_mul_u32_u24 v7, 27, v6
    v_sub_u32 v7, v2, v7
    v_mul_u32_u24 v8, 57, v7
    v_lshrrev_b32 v8, 9, v8
    v_bfe_u32 v9, v6, 1, 2
    v_and_or_b32 v9, v6, 56, v9
    v_and_b32 v6, 1, v6
    v_lshl_or_b32 v9, v6, 2, v9
    v_mul_u32_u24 v9, 3456, v9
    v_lshl_add_u32 v9, v7, 4, v9
    v_mul_u32_u24 v8, 1008, v8
    v_add3_u32 v21, v9, v8, s75
    s_add_u32 m0, s71, 81920
    v_and_b32 v2, 3, v1
    v_lshl_add_u32 v21, v2, 2, v21
    buffer_load_dword v21, s[40:43], s65 offen lds
    s_add_u32 s64, s64, 128
    s_add_u32 s65, s65, 221184
    s_add_u32 s11, s11, 1
    s_cmp_eq_u32 s11, 9
    s_cselect_b32 s11, 0, s11
    s_cselect_b32 s64, 0, s64
    s_cselect_b32 s65, 0, s65
    s_cmp_lt_u32 s3, 2
    s_cselect_b32 s66, s64, s65
    s_add_u32 m0, s67, 18432
    s_and_b32 s80, s5, 7
    s_lshr_b32 s81, s5, 4
    s_lshl_b32 s77, s4, 1
    s_add_u32 s81, s81, s77
    s_lshl_b32 s81, s81, 2
    s_add_u32 s81, s81, s3
    s_mul_i32 s81, s81, 9
    s_mul_i32 s78, s80, 165888
    s_mul_i32 s79, s81, 144
    s_add_u32 s78, s78, s79
    s_add_u32 s78, s78, 4734976
    s_bitcmp1_b32 s5, 3
    s_cselect_b32 s79, 82944, 0
    s_cselect_b32 s82, s26, s20
    s_cselect_b32 s83, s27, s21
    s_add_u32 s78, s78, s79
    v_lshlrev_b32 v238, 4, v1
    buffer_load_dwordx4 v10, s[36:39], s64 offen lds
    s_add_u32 m0, s67, 22528
    v_add_u32 v238, s78, v238
    s_mul_i32 s80, s80, 144
    s_movk_i32 s77, 512
    v_add_u32 v239, 64, v1
    v_min_u32 v239, 80, v239
    v_mov_b32 v253, 0
    v_mov_b32 v250, 64
    v_mul_u32_u24 v240, 57, v1
    v_lshrrev_b32 v240, 9, v240
    v_mul_u32_u24 v241, 9, v240
    v_sub_u32 v241, v1, v241
    v_lshl_add_u32 v241, v241, 4, s80
    v_add_u32 v240, s81, v240
    v_bfe_u32 v242, v240, 1, 2
    buffer_load_dwordx4 v11, s[36:39], s64 offen lds
    s_add_u32 m0, s67, 26624
    v_and_b32 v243, 1, v240
    v_lshl_or_b32 v242, v243, 2, v242
    v_lshrrev_b32 v243, 4, v240
    v_mul_u32_u24 v244, 18, v243
    v_and_b32 v243, 1, v243
    v_lshl_add_u32 v244, v243, 1, v244
    v_and_b32 v243, 8, v240
    v_add3_u32 v244, v244, v243, v242
    v_lshrrev_b32 v243, 3, v240
    v_mul_u32_u24 v245, 72, v243
    v_lshrrev_b32 v243, 1, v242
    v_mad_u32_u24 v245, v243, 18, v245
    v_and_b32 v243, 1, v243
    v_xor_b32 v243, 1, v243
    buffer_load_dwordx4 v12, s[36:39], s64 offen lds
    s_add_u32 m0, s67, 30720
    v_lshl_add_u32 v245, v243, 4, v245
    v_and_b32 v243, 1, v242
    v_add_u32 v245, v245, v243
    v_subrev_u32 v245, 4608, v245
    v_cmp_gt_u32 s[78:79], s77, v240
    s_nop 1
    v_cndmask_b32 v244, v245, v244, s[78:79]
    v_mul_u32_u24 v244, 1152, v244
    v_add_u32 v236, v244, v241
    v_mul_u32_u24 v240, 57, v239
    v_lshrrev_b32 v240, 9, v240
    v_mul_u32_u24 v241, 9, v240
    v_sub_u32 v241, v239, v241
    v_lshl_add_u32 v241, v241, 4, s80
    v_add_u32 v240, s81, v240
    buffer_load_dwordx4 v13, s[36:39], s64 offen lds
    s_add_u32 m0, s67, 82944
    v_bfe_u32 v242, v240, 1, 2
    v_and_b32 v243, 1, v240
    v_lshl_or_b32 v242, v243, 2, v242
    v_lshrrev_b32 v243, 4, v240
    v_mul_u32_u24 v244, 18, v243
    v_and_b32 v243, 1, v243
    v_lshl_add_u32 v244, v243, 1, v244
    v_and_b32 v243, 8, v240
    v_add3_u32 v244, v244, v243, v242
    v_lshrrev_b32 v243, 3, v240
    v_mul_u32_u24 v245, 72, v243
    v_lshrrev_b32 v243, 1, v242
    v_mad_u32_u24 v245, v243, 18, v245
    v_and_b32 v243, 1, v243
    buffer_load_dwordx4 v14, s[40:43], s65 offen lds
    s_add_u32 m0, s67, 87040
    v_xor_b32 v243, 1, v243
    v_lshl_add_u32 v245, v243, 4, v245
    v_and_b32 v243, 1, v242
    v_add_u32 v245, v245, v243
    v_subrev_u32 v245, 4608, v245
    v_cmp_gt_u32 s[78:79], s77, v240
    s_nop 1
    v_cndmask_b32 v244, v245, v244, s[78:79]
    v_mul_u32_u24 v244, 1152, v244
    v_add_u32 v237, v244, v241
    v_lshrrev_b32 v2, 4, v1
    v_and_b32 v3, 15, v1
    v_bfe_u32 v4, v1, 2, 2
    v_and_b32 v5, 3, v1
    s_and_b32 s100, s3, 1
    buffer_load_dwordx4 v15, s[40:43], s65 offen lds
    s_add_u32 m0, s67, 91136
    v_and_b32 v6, 7, v3
    v_xor_b32 v7, v2, v6
    v_lshlrev_b32 v7, 4, v7
    v_lshl_add_u32 v8, v3, 7, v7
    s_lshl_b32 s72, s100, 13
    v_add_u32 v36, s72, v8
    v_xor_b32 v37, 64, v36
    v_xor_b32 v38, 0x2000, v36
    v_xor_b32 v39, 0x2040, v36
    v_add_u32 v40, 16384, v8
    v_xor_b32 v41, 64, v40
    v_lshlrev_b32 v6, 2, v2
    v_add_u32 v6, v6, v4
    v_mul_u32_u24 v6, 864, v6
    buffer_load_dwordx4 v16, s[40:43], s65 offen lds
    s_add_u32 m0, s67, 95232
    s_mul_i32 s72, s3, 36
    s_lshl_b32 s73, s100, 2
    s_add_u32 s72, s72, s73
    s_add_u32 s72, s72, 55296
    v_lshl_add_u32 v7, v5, 3, v6
    v_add_u32 v42, s72, v7
    v_add_u32 v43, 55296, v42
    s_lshr_b32 s74, s3, 1
    s_mul_i32 s72, s74, 288
    s_add_u32 s72, s72, 55328
    v_mul_u32_u24 v7, 72, v5
    v_add3_u32 v6, v6, v7, s72
    v_lshl_add_u32 v7, v2, 3, v4
    v_lshlrev_b32 v7, 3, v7
    buffer_load_dwordx4 v17, s[40:43], s65 offen lds
    s_add_u32 m0, s67, 99328
    v_lshrrev_b32 v8, 1, v5
    v_and_b32 v8, s74, v8
    v_cmp_eq_u32 vcc, 1, v8
    v_add_u32 v8, 0, v6
    v_add_u32 v9, 138240, v7
    v_cndmask_b32 v44, v8, v9, vcc
    v_add_u32 v8, 432, v6
    v_add_u32 v9, 138272, v7
    v_cndmask_b32 v45, v8, v9, vcc
    v_add_u32 v8, 13824, v6
    v_add_u32 v9, 138496, v7
    v_cndmask_b32 v46, v8, v9, vcc
    v_add_u32 v8, 14256, v6
    v_add_u32 v9, 138528, v7
    buffer_load_dwordx4 v18, s[40:43], s65 offen lds
    s_add_u32 m0, s67, 103424
    v_cndmask_b32 v47, v8, v9, vcc
    v_mov_b32 v8, 512
    v_mov_b32 v9, 27648
    v_cndmask_b32 v48, v9, v8, vcc
    v_mov_b32 v9, 4294912000
    v_cndmask_b32 v49, v9, v8, vcc
    s_getreg_b32 s10, hwreg(HW_REG_XCC_ID, 0, 4)
    s_add_u32 s10, s10, 1
    s_lshl_b32 s72, s4, 2
    s_add_u32 s72, s72, 128
    v_mov_b32 v91, s72
    v_mov_b32 v88, s10
    s_mov_b32 s12, 0
    s_sub_u32 s72, 9, s14
    buffer_load_dwordx4 v19, s[40:43], s65 offen lds
    s_mov_b32 m0, s69
    v_lshrrev_b32 v6, 5, v0
    v_add_u32 v6, s72, v6
    v_subrev_u32 v7, 9, v6
    v_min_u32 v6, v6, v7
    v_and_b32 v7, 31, v0
    v_lshlrev_b32 v7, 4, v7
    v_lshl_add_u32 v6, v6, 9, v7
    v_add_u32 v6, 138240, v6
    s_sub_u32 s72, 8, s14
    s_lshl_b32 s72, s72, 9
    s_add_u32 s72, s72, 138240
    v_min_u32 v7, 31, v0
    v_lshlrev_b32 v7, 4, v7
    v_add_u32 v7, s72, v7
    buffer_load_dwordx4 v20, s[44:47], s66 offen lds
    s_add_u32 m0, s71, 109568
    v_mov_b32 v221, 0
    v_mov_b32 v223, 0
    v_mov_b32 v225, 0
    v_mov_b32 v227, 0
    buffer_load_dword v21, s[40:43], s65 offen lds
    global_load_dwordx4 v[228:231], v236, s[82:83]
    s_mov_b64 exec, 0x1ffff
    global_load_dwordx4 v[232:235], v237, s[82:83]
    s_mov_b64 exec, -1
    s_add_u32 s64, s64, 128
    s_add_u32 s65, s65, 221184
    s_add_u32 s11, s11, 1
    s_cmp_eq_u32 s11, 9
    s_cselect_b32 s11, 0, s11
    s_cselect_b32 s64, 0, s64
    s_cselect_b32 s65, 0, s65
    s_cmp_lt_u32 s3, 2
    s_cselect_b32 s66, s64, s65
    s_cmp_eq_u32 s76, 0
    s_cbranch_scc0 .nopub_4
    s_waitcnt vmcnt(26)
    s_mov_b64 exec, 1
    global_store_dword v91, v88, s[32:33]
    s_mov_b64 exec, -1
.nopub_4:
    s_cmp_eq_u32 s3, 0
    s_cbranch_scc1 .Lpad1
    s_cmp_eq_u32 s3, 1
    s_cbranch_scc1 .Lpad2
    s_cmp_eq_u32 s3, 2
    s_cbranch_scc1 .Lpad3
    s_branch .Lpad4
.Lpret:
    s_waitcnt vmcnt(14)
    s_cmp_eq_u32 s7, 0
    s_cbranch_scc0 .nogate2_5
    v_and_b32 v220, 0xffff, v30
    v_lshrrev_b32 v222, 16, v30
    v_and_b32 v224, 0xffff, v90
    v_lshrrev_b32 v226, 16, v90
    ds_write_b128 v6, v[220:223]
    ds_write_b128 v7, v[224:227]
    s_waitcnt lgkmcnt(0)
.nogate2_5:
    s_barrier
    ds_read_b64_tr_b16 a[36:37], v42 offset:0
    ds_read_b64_tr_b16 a[38:39], v42 offset:432
    s_add_u32 m0, s67, 36864
    s_nop 0
    buffer_load_dwordx4 v10, s[36:39], s64 offen lds
    ds_read_b128 a[0:3], v36 offset:0
    ds_read_b128 a[4:7], v36 offset:2048
    s_add_u32 m0, s67, 40960
    s_nop 0
    buffer_load_dwordx4 v11, s[36:39], s64 offen lds
    ds_read_b128 a[8:11], v36 offset:4096
    ds_read_b128 a[12:15], v36 offset:6144
    ds_read_b128 a[16:19], v38 offset:0
    s_add_u32 m0, s67, 45056
    s_nop 0
    buffer_load_dwordx4 v12, s[36:39], s64 offen lds
    ds_read_b128 a[20:23], v38 offset:2048
    ds_read_b128 a[24:27], v38 offset:4096
    ds_read_b128 a[28:31], v38 offset:6144
    s_add_u32 m0, s67, 49152
    s_nop 0
    buffer_load_dwordx4 v13, s[36:39], s64 offen lds
    ds_read_b64_tr_b16 a[40:41], v42 offset:144
    ds_read_b64_tr_b16 a[42:43], v42 offset:576
    s_add_u32 m0, s67, 110592
    s_nop 0
    buffer_load_dwordx4 v14, s[40:43], s65 offen lds
    ds_read_b128 a[32:35], v40 offset:0
    ds_read_b64_tr_b16 a[44:45], v42 offset:288
    ds_read_b64_tr_b16 a[46:47], v42 offset:720
    s_add_u32 m0, s67, 114688
    s_nop 0
    buffer_load_dwordx4 v15, s[40:43], s65 offen lds
    ds_read_b64_tr_b16 a[48:49], v44 offset:0
    ds_read_b64_tr_b16 a[50:51], v45 offset:0
    s_add_u32 m0, s67, 118784
    s_nop 0
    buffer_load_dwordx4 v16, s[40:43], s65 offen lds
    s_add_u32 m0, s67, 122880
    s_nop 0
    buffer_load_dwordx4 v17, s[40:43], s65 offen lds
    v_mov_b32 v92, 1
    s_mov_b32 s48, s34
    s_and_b32 s49, s35, 0xffff
    s_mov_b32 s50, 4726784
    s_mov_b32 s51, 0x20000
    s_mul_i32 s72, s6, 147456
    s_mul_i32 s73, s8, 2359296
    s_add_u32 s72, s72, s73
    s_lshl_b32 s73, s9, 11
    s_lshl_b32 s74, s3, 9
    s_add_u32 s73, s73, s74
    s_add_u32 s73, s73, s72
    v_and_b32 v220, 1, v2
    v_mul_u32_u24 v220, 18432, v220
    v_lshrrev_b32 v7, 1, v2
    v_lshl_add_u32 v220, v7, 8, v220
    v_lshl_add_u32 v220, v3, 4, v220
    v_add_u32 v220, s73, v220
    s_lshl_b32 s73, s9, 8
    s_lshl_b32 s74, s3, 2
    s_add_u32 s73, s73, s74
    s_add_u32 s73, s73, s72
    s_add_u32 s73, s73, 16384
    v_mul_u32_u24 v7, 18432, v2
    s_waitcnt lgkmcnt(0)
    s_add_u32 m0, s67, 126976
    v_mfma_f32_16x16x32_bf16 v[96:99], a[36:39], a[0:3], 0
    buffer_load_dwordx4 v18, s[40:43], s65 offen lds
    ds_read_b64_tr_b16 a[88:89], v42 offset:13824
    v_lshl_add_u32 v7, v3, 4, v7
    v_mfma_f32_16x16x32_bf16 v[100:103], a[36:39], a[4:7], 0
    ds_read_b64_tr_b16 a[90:91], v42 offset:14256
    v_add_u32 v7, s73, v7
    s_mul_i32 s72, s100, 73728
    v_mfma_f32_16x16x32_bf16 v[104:107], a[36:39], a[8:11], 0
    ds_read_b128 a[52:55], v37 offset:0
    s_sub_u32 s73, 73728, s72
    v_add_u32 v83, s72, v220
    v_mfma_f32_16x16x32_bf16 v[108:111], a[36:39], a[12:15], 0
    v_add_u32 v84, s73, v220
    v_add_u32 v85, s72, v7
    s_add_u32 m0, s67, 131072
    v_mfma_f32_16x16x32_bf16 v[112:115], a[36:39], a[16:19], 0
    buffer_load_dwordx4 v19, s[40:43], s65 offen lds
    ds_read_b128 a[56:59], v37 offset:2048
    v_add_u32 v86, s73, v7
    v_mfma_f32_16x16x32_bf16 v[116:119], a[36:39], a[20:23], 0
    ds_read_b128 a[60:63], v37 offset:4096
    s_lshr_b32 s15, s5, 2
    s_mul_i32 s72, s15, 165888
    v_mfma_f32_16x16x32_bf16 v[120:123], a[36:39], a[24:27], 0
    s_add_u32 s72, s72, 4734976
    s_add_u32 s73, s72, 82944
    s_mov_b32 m0, s70
    v_mfma_f32_16x16x32_bf16 v[124:127], a[36:39], a[28:31], 0
    buffer_load_dwordx4 v20, s[44:47], s66 offen lds
    ds_read_b128 a[64:67], v37 offset:6144
    v_mfma_f32_16x16x32_bf16 v[128:131], a[40:43], a[0:3], 0
    ds_read_b128 a[68:71], v39 offset:0
    s_add_u32 s52, s34, s72
    s_addc_u32 s53, s35, 0
    v_mfma_f32_16x16x32_bf16 v[132:135], a[40:43], a[4:7], 0
    ds_read_b128 a[72:75], v39 offset:2048
    s_add_u32 s56, s34, s73
    s_addc_u32 s57, s35, 0
    v_mfma_f32_16x16x32_bf16 v[136:139], a[40:43], a[8:11], 0
    s_and_b32 s53, s53, 0xffff
    s_and_b32 s57, s57, 0xffff
    s_add_u32 m0, s71, 137216
    v_mfma_f32_16x16x32_bf16 v[140:143], a[40:43], a[12:15], 0
    buffer_load_dword v21, s[40:43], s65 offen lds
    ds_read_b128 a[76:79], v39 offset:4096
    s_mov_b32 s54, 82944
    v_mfma_f32_16x16x32_bf16 v[144:147], a[40:43], a[16:19], 0
    ds_read_b128 a[80:83], v39 offset:6144
    s_add_u32 s64, s64, 128
    s_mov_b32 s58, 82944
    v_mfma_f32_16x16x32_bf16 v[148:151], a[40:43], a[20:23], 0
    s_add_u32 s65, s65, 221184
    s_mov_b32 s55, 0x20000
    s_mov_b32 s59, 0x20000
    v_mfma_f32_16x16x32_bf16 v[152:155], a[40:43], a[24:27], 0
    ds_read_b64_tr_b16 a[92:93], v42 offset:13968
    v_lshlrev_b32 v22, 4, v0
    v_add_u32 v23, 4096, v22
    v_mfma_f32_16x16x32_bf16 v[156:159], a[40:43], a[28:31], 0
    ds_read_b64_tr_b16 a[94:95], v42 offset:14400
    s_add_u32 s11, s11, 1
    v_add_u32 v24, 8192, v22
    v_mfma_f32_16x16x32_bf16 v[192:195], a[40:43], a[32:35], 0
    ds_read_b128 a[84:87], v41 offset:0
    v_add_u32 v25, 12288, v22
    v_add_u32 v26, 16384, v22
    v_mfma_f32_16x16x32_bf16 v[160:163], a[0:3], a[44:47], 0
    s_cmp_eq_u32 s11, 9
    s_cselect_b32 s11, 0, s11
    s_cselect_b32 s64, 0, s64
    s_cselect_b32 s65, 0, s65
    v_mfma_f32_16x16x32_bf16 v[164:167], a[4:7], a[44:47], 0
    ds_read_b64_tr_b16 a[96:97], v42 offset:14112
    v_add_u32 v27, 20480, v22
    s_movk_i32 s72, 22528
    v_mfma_f32_16x16x32_bf16 v[168:171], a[8:11], a[44:47], 0
    ds_read_b64_tr_b16 a[98:99], v42 offset:14544
    s_cmp_lt_u32 s3, 2
    s_cselect_b32 s66, s64, s65
    v_mfma_f32_16x16x32_bf16 v[172:175], a[12:15], a[44:47], 0
    s_mov_b32 s74, 55296
    v_mfma_f32_16x16x32_bf16 v[176:179], a[16:19], a[44:47], 0
    ds_read_b64_tr_b16 a[100:101], v46 offset:0
    v_mfma_f32_16x16x32_bf16 v[180:183], a[20:23], a[44:47], 0
    ds_read_b64_tr_b16 a[102:103], v47 offset:0
    v_mfma_f32_16x16x32_bf16 v[184:187], a[24:27], a[44:47], 0
    s_cmp_lt_u32 s3, 2
    s_cselect_b32 s72, 16384, s72
    s_cselect_b32 s73, 0, s74
    v_mfma_f32_16x16x32_bf16 v[188:191], a[28:31], a[44:47], 0
    v_add_u32 v44, v48, v44
    v_add_u32 v28, s72, v22
    v_lshlrev_b32 v29, 2, v0
    v_mfma_f32_16x16x32_bf16 v[196:199], a[32:35], a[44:47], 0
    v_add_u32 v45, v48, v45
    v_add_u32 v29, 26624, v29
    v_add_u32 v32, s74, v26
    v_mfma_f32_16x16x32_bf16 v[200:203], a[48:51], a[0:3], 0
    v_add_u32 v46, v48, v46
    v_add_u32 v33, s74, v27
    v_add_u32 v34, s74, v28
    v_mfma_f32_16x16x32_bf16 v[204:207], a[48:51], a[4:7], 0
    v_add_u32 v47, v48, v47
    v_add_u32 v35, s74, v29
    v_add_u32 v95, s73, v28
    v_mfma_f32_16x16x32_bf16 v[208:211], a[48:51], a[8:11], 0
    v_lshlrev_b32 v6, 2, v2
    v_sub_u32 v6, v3, v6
    v_mov_b32 v9, 4048155338
    v_mfma_f32_16x16x32_bf16 v[212:215], a[48:51], a[12:15], 0
    s_mov_b32 s82, -1
    s_mov_b32 s83, 0
    v_subrev_u32 v7, 0, v6
    v_mfma_f32_16x16x32_bf16 v[216:219], a[48:51], a[32:35], 0
    v_cmp_gt_u32 vcc, 8, v7
    v_cmp_gt_i32 s[78:79], -8, v7
    v_cmp_le_i32 s[80:81], 0, v7
    s_waitcnt vmcnt(12) lgkmcnt(0)
    s_barrier
    v_mfma_f32_16x16x32_bf16 v[96:99], a[88:91], a[52:55], v[96:99]
    ds_read_b64_tr_b16 a[36:37], v42 offset:27648
    v_cndmask_b32 v50, v9, 0, vcc
    v_cndmask_b32 v54, v9, 0, s[78:79]
    v_mfma_f32_16x16x32_bf16 v[100:103], a[88:91], a[56:59], v[100:103]
    s_branch .Lsk1
.Lpad1:
    s_branch .Lpret
.Lsk1:
    ds_read_b64_tr_b16 a[38:39], v42 offset:28080
    v_cndmask_b32 v220, 0, -1, s[80:81]
    s_add_u32 m0, s67, 0
    v_mfma_f32_16x16x32_bf16 v[104:107], a[88:91], a[60:63], v[104:107]
    buffer_load_dwordx4 v10, s[36:39], s64 offen lds
    ds_read_b128 a[0:3], v36 offset:18432
    s_andn2_b64 s[78:79], s[82:83], s[80:81]
    v_mfma_f32_16x16x32_bf16 v[108:111], a[88:91], a[64:67], v[108:111]
    v_cndmask_b32 v224, v9, 0, s[78:79]
    v_subrev_u32 v7, 1, v6
    v_cmp_gt_u32 vcc, 8, v7
    v_mfma_f32_16x16x32_bf16 v[112:115], a[88:91], a[68:71], v[112:115]
    ds_read_b128 a[4:7], v36 offset:20480
    v_cmp_gt_i32 s[78:79], -8, v7
    s_add_u32 m0, s67, 4096
    v_mfma_f32_16x16x32_bf16 v[116:119], a[88:91], a[72:75], v[116:119]
    buffer_load_dwordx4 v11, s[36:39], s64 offen lds
    ds_read_b128 a[8:11], v36 offset:22528
    v_cmp_le_i32 s[80:81], 0, v7
    v_mfma_f32_16x16x32_bf16 v[120:123], a[88:91], a[76:79], v[120:123]
    v_cndmask_b32 v51, v9, 0, vcc
    v_cndmask_b32 v55, v9, 0, s[78:79]
    v_cndmask_b32 v221, 0, -1, s[80:81]
    v_mfma_f32_16x16x32_bf16 v[124:127], a[88:91], a[80:83], v[124:127]
    ds_read_b128 a[12:15], v36 offset:24576
    s_andn2_b64 s[78:79], s[82:83], s[80:81]
    v_cndmask_b32 v225, v9, 0, s[78:79]
    v_mfma_f32_16x16x32_bf16 v[128:131], a[92:95], a[52:55], v[128:131]
    ds_read_b128 a[16:19], v38 offset:18432
    v_subrev_u32 v7, 2, v6
    s_add_u32 m0, s67, 8192
    v_mfma_f32_16x16x32_bf16 v[132:135], a[92:95], a[56:59], v[132:135]
    buffer_load_dwordx4 v12, s[36:39], s64 offen lds
    ds_read_b128 a[20:23], v38 offset:20480
    v_cmp_gt_u32 vcc, 8, v7
    v_mfma_f32_16x16x32_bf16 v[136:139], a[92:95], a[60:63], v[136:139]
    v_cmp_gt_i32 s[78:79], -8, v7
    v_cmp_le_i32 s[80:81], 0, v7
    v_cndmask_b32 v52, v9, 0, vcc
    v_mfma_f32_16x16x32_bf16 v[140:143], a[92:95], a[64:67], v[140:143]
    ds_read_b128 a[24:27], v38 offset:22528
    v_cndmask_b32 v56, v9, 0, s[78:79]
    v_cndmask_b32 v222, 0, -1, s[80:81]
    v_mfma_f32_16x16x32_bf16 v[144:147], a[92:95], a[68:71], v[144:147]
    ds_read_b128 a[28:31], v38 offset:24576
    s_andn2_b64 s[78:79], s[82:83], s[80:81]
    s_add_u32 m0, s67, 12288
    v_mfma_f32_16x16x32_bf16 v[148:151], a[92:95], a[72:75], v[148:151]
    buffer_load_dwordx4 v13, s[36:39], s64 offen lds
    v_cndmask_b32 v226, v9, 0, s[78:79]
    v_subrev_u32 v7, 3, v6
    v_mfma_f32_16x16x32_bf16 v[152:155], a[92:95], a[76:79], v[152:155]
    ds_read_b64_tr_b16 a[40:41], v42 offset:27792
    v_cmp_gt_u32 vcc, 8, v7
    v_cmp_gt_i32 s[78:79], -8, v7
    v_mfma_f32_16x16x32_bf16 v[156:159], a[92:95], a[80:83], v[156:159]
    ds_read_b64_tr_b16 a[42:43], v42 offset:28224
    v_cmp_le_i32 s[80:81], 0, v7
    s_add_u32 m0, s67, 55296
    v_mfma_f32_16x16x32_bf16 v[192:195], a[92:95], a[84:87], v[192:195]
    buffer_load_dwordx4 v14, s[40:43], s65 offen lds
    ds_read_b128 a[32:35], v40 offset:18432
    v_cndmask_b32 v53, v9, 0, vcc
    v_mfma_f32_16x16x32_bf16 v[160:163], a[52:55], a[96:99], v[160:163]
    v_cndmask_b32 v57, v9, 0, s[78:79]
    v_cndmask_b32 v223, 0, -1, s[80:81]
    s_andn2_b64 s[78:79], s[82:83], s[80:81]
    v_mfma_f32_16x16x32_bf16 v[164:167], a[56:59], a[96:99], v[164:167]
    ds_read_b64_tr_b16 a[44:45], v42 offset:27936
    v_cndmask_b32 v227, v9, 0, s[78:79]
    v_and_b32 v220, 0xffff, v220
    v_mfma_f32_16x16x32_bf16 v[168:171], a[60:63], a[96:99], v[168:171]
    ds_read_b64_tr_b16 a[46:47], v42 offset:28368
    v_and_b32 v221, 0xffff0000, v221
    s_add_u32 m0, s67, 59392
    v_mfma_f32_16x16x32_bf16 v[172:175], a[64:67], a[96:99], v[172:175]
    buffer_load_dwordx4 v15, s[40:43], s65 offen lds
    v_and_b32 v222, 0xffff, v222
    v_and_b32 v223, 0xffff0000, v223
    v_mfma_f32_16x16x32_bf16 v[176:179], a[68:71], a[96:99], v[176:179]
    ds_read_b64_tr_b16 a[48:49], v44 offset:0
    v_or_b32 v66, v220, v221
    v_or_b32 v67, v222, v223
    v_mfma_f32_16x16x32_bf16 v[180:183], a[72:75], a[96:99], v[180:183]
    ds_read_b64_tr_b16 a[50:51], v45 offset:0
    v_not_b32 v68, v66
    v_not_b32 v69, v67
    v_mfma_f32_16x16x32_bf16 v[184:187], a[76:79], a[96:99], v[184:187]
    s_cmp_eq_u32 s100, 0
    s_cselect_b64 vcc, -1, 0
    s_add_u32 m0, s67, 63488
    v_mfma_f32_16x16x32_bf16 v[188:191], a[80:83], a[96:99], v[188:191]
    buffer_load_dwordx4 v16, s[40:43], s65 offen lds
    s_cmp_eq_u32 s6, 0
    s_cselect_b64 s[78:79], -1, 0
    v_mfma_f32_16x16x32_bf16 v[196:199], a[84:87], a[96:99], v[196:199]
    v_cndmask_b32 v7, v54, v224, vcc
    v_cndmask_b32 v8, v224, v54, vcc
    v_cndmask_b32 v58, v7, v9, s[78:79]
    v_mfma_f32_16x16x32_bf16 v[200:203], a[100:103], a[52:55], v[200:203]
    v_cndmask_b32 v62, v8, v9, s[78:79]
    v_cndmask_b32 v7, v55, v225, vcc
    s_add_u32 m0, s67, 67584
    v_mfma_f32_16x16x32_bf16 v[204:207], a[100:103], a[56:59], v[204:207]
    buffer_load_dwordx4 v17, s[40:43], s65 offen lds
    v_cndmask_b32 v8, v225, v55, vcc
    v_cndmask_b32 v59, v7, v9, s[78:79]
    v_mfma_f32_16x16x32_bf16 v[208:211], a[100:103], a[60:63], v[208:211]
    v_cndmask_b32 v63, v8, v9, s[78:79]
    v_cndmask_b32 v7, v56, v226, vcc
    v_cndmask_b32 v8, v226, v56, vcc
    v_mfma_f32_16x16x32_bf16 v[212:215], a[100:103], a[64:67], v[212:215]
    v_cndmask_b32 v60, v7, v9, s[78:79]
    v_cndmask_b32 v64, v8, v9, s[78:79]
    v_cndmask_b32 v7, v57, v227, vcc
    v_mfma_f32_16x16x32_bf16 v[216:219], a[100:103], a[84:87], v[216:219]
    v_cndmask_b32 v8, v227, v57, vcc
    v_cndmask_b32 v61, v7, v9, s[78:79]
    s_waitcnt lgkmcnt(0)
    s_add_u32 m0, s67, 71680
    v_mfma_f32_16x16x32_bf16 v[96:99], a[36:39], a[0:3], v[96:99]
    buffer_load_dwordx4 v18, s[40:43], s65 offen lds
    ds_read_b64_tr_b16 a[88:89], v42 offset:41472
    v_cndmask_b32 v65, v8, v9, s[78:79]
    v_mfma_f32_16x16x32_bf16 v[100:103], a[36:39], a[4:7], v[100:103]
    ds_read_b64_tr_b16 a[90:91], v42 offset:41904
    s_lshr_b32 s74, s3, 1
    s_mul_i32 s72, s3, 2560
    v_mfma_f32_16x16x32_bf16 v[104:107], a[36:39], a[8:11], v[104:107]
    ds_read_b128 a[52:55], v37 offset:18432
    s_add_u32 s72, s72, 147456
    v_lshlrev_b32 v6, 3, v1
    v_mfma_f32_16x16x32_bf16 v[108:111], a[36:39], a[12:15], v[108:111]
    v_add_u32 v70, s72, v6
    s_lshl_b32 s72, s74, 7
    s_add_u32 m0, s67, 75776
    v_mfma_f32_16x16x32_bf16 v[112:115], a[36:39], a[16:19], v[112:115]
    buffer_load_dwordx4 v19, s[40:43], s65 offen lds
    ds_read_b128 a[56:59], v37 offset:20480
    s_lshl_b32 s73, s100, 2
    v_mfma_f32_16x16x32_bf16 v[116:119], a[36:39], a[20:23], v[116:119]
    ds_read_b128 a[60:63], v37 offset:22528
    s_add_u32 s72, s72, s73
    s_add_u32 s72, s72, 147456
    v_mfma_f32_16x16x32_bf16 v[120:123], a[36:39], a[24:27], v[120:123]
    v_lshlrev_b32 v6, 3, v3
    v_add_u32 v6, s72, v6
    s_mov_b32 m0, s68
    v_mfma_f32_16x16x32_bf16 v[124:127], a[36:39], a[28:31], v[124:127]
    buffer_load_dwordx4 v20, s[44:47], s66 offen lds
    ds_read_b128 a[64:67], v37 offset:24576
    s_mul_i32 s72, s100, 2560
    v_mfma_f32_16x16x32_bf16 v[128:131], a[40:43], a[0:3], v[128:131]
    ds_read_b128 a[68:71], v39 offset:18432
    s_sub_u32 s73, 2560, s72
    v_mov_b32 v9, 157696
    v_mfma_f32_16x16x32_bf16 v[132:135], a[40:43], a[4:7], v[132:135]
    ds_read_b128 a[72:75], v39 offset:20480
    v_cmp_eq_u32 vcc, 0, v2
    v_add_u32 v7, s72, v6
    v_mfma_f32_16x16x32_bf16 v[136:139], a[40:43], a[8:11], v[136:139]
    v_add_u32 v8, s73, v6
    v_add_u32 v73, 256, v7
    s_add_u32 m0, s71, 81920
    v_mfma_f32_16x16x32_bf16 v[140:143], a[40:43], a[12:15], v[140:143]
    buffer_load_dword v21, s[40:43], s65 offen lds
    ds_read_b128 a[76:79], v39 offset:22528
    v_add_u32 v74, 256, v8
    v_mfma_f32_16x16x32_bf16 v[144:147], a[40:43], a[16:19], v[144:147]
    ds_read_b128 a[80:83], v39 offset:24576
    s_add_u32 s64, s64, 128
    v_cndmask_b32 v71, v9, v7, vcc
    v_mfma_f32_16x16x32_bf16 v[148:151], a[40:43], a[20:23], v[148:151]
    s_add_u32 s65, s65, 221184
    global_store_dwordx4 v238, v[228:231], s[34:35] sc1
    v_cndmask_b32 v72, v9, v8, vcc
    v_mfma_f32_16x16x32_bf16 v[152:155], a[40:43], a[24:27], v[152:155]
    ds_read_b64_tr_b16 a[92:93], v42 offset:41616
    v_lshl_add_u32 v6, v2, 2, v4
    v_lshlrev_b32 v6, 3, v6
    v_mfma_f32_16x16x32_bf16 v[156:159], a[40:43], a[28:31], v[156:159]
    ds_read_b64_tr_b16 a[94:95], v42 offset:42048
    s_add_u32 s11, s11, 1
    s_mov_b64 exec, 0x1ffff
    global_store_dwordx4 v238, v[232:235], s[34:35] offset:1024 sc1
    s_mov_b64 exec, -1
    v_mfma_f32_16x16x32_bf16 v[192:195], a[40:43], a[32:35], v[192:195]
    ds_read_b128 a[84:87], v41 offset:18432
    s_lshl_b32 s75, s74, 7
    s_add_u32 s75, s75, 152576
    v_mfma_f32_16x16x32_bf16 v[160:163], a[0:3], a[44:47], v[160:163]
    s_cmp_eq_u32 s11, 9
    s_cselect_b32 s11, 0, s11
    s_cselect_b32 s64, 0, s64
    s_cselect_b32 s65, 0, s65
    v_mfma_f32_16x16x32_bf16 v[164:167], a[4:7], a[44:47], v[164:167]
    ds_read_b64_tr_b16 a[96:97], v42 offset:41760
    v_add_u32 v6, s75, v6
    v_add_u32 v7, s72, v6
    v_mfma_f32_16x16x32_bf16 v[168:171], a[8:11], a[44:47], v[168:171]
    ds_read_b64_tr_b16 a[98:99], v42 offset:42192
    s_cmp_lt_u32 s3, 2
    s_cselect_b32 s66, s64, s65
    v_mfma_f32_16x16x32_bf16 v[172:175], a[12:15], a[44:47], v[172:175]
    v_add_u32 v8, s73, v6
    v_cmp_eq_u32 vcc, 0, v5
    s_nop 1
    v_cndmask_b32 v75, v9, v7, vcc
    v_mfma_f32_16x16x32_bf16 v[176:179], a[16:19], a[44:47], v[176:179]
    ds_read_b64_tr_b16 a[100:101], v46 offset:0
    v_cndmask_b32 v79, v9, v8, vcc
    v_cmp_eq_u32 vcc, 1, v5
    v_mfma_f32_16x16x32_bf16 v[180:183], a[20:23], a[44:47], v[180:183]
    ds_read_b64_tr_b16 a[102:103], v47 offset:0
    v_cndmask_b32 v76, v9, v7, vcc
    v_cndmask_b32 v80, v9, v8, vcc
    v_mfma_f32_16x16x32_bf16 v[184:187], a[24:27], a[44:47], v[184:187]
    v_cmp_eq_u32 vcc, 2, v5
    s_nop 1
    v_cndmask_b32 v77, v9, v7, vcc
    v_cndmask_b32 v81, v9, v8, vcc
    v_mfma_f32_16x16x32_bf16 v[188:191], a[28:31], a[44:47], v[188:191]
    v_add_u32 v44, v48, v44
    v_cmp_eq_u32 vcc, 3, v5
    s_nop 1
    v_cndmask_b32 v78, v9, v7, vcc
    v_mfma_f32_16x16x32_bf16 v[196:199], a[32:35], a[44:47], v[196:199]
    v_add_u32 v45, v48, v45
    v_cndmask_b32 v82, v9, v8, vcc
    v_min_u32 v6, 4, v1
    v_mfma_f32_16x16x32_bf16 v[200:203], a[48:51], a[0:3], v[200:203]
    v_add_u32 v46, v48, v46
    v_lshlrev_b32 v6, 9, v6
    v_add_u32 v6, 157696, v6
    v_mfma_f32_16x16x32_bf16 v[204:207], a[48:51], a[4:7], v[204:207]
    v_add_u32 v47, v48, v47
    v_mov_b32 v8, 0
    v_mov_b32 v9, 0
    v_mfma_f32_16x16x32_bf16 v[208:211], a[48:51], a[8:11], v[208:211]
    ds_write_b64 v6, v[8:9]
    s_lshl_b32 s73, s6, 9
    s_lshl_b32 s74, s100, 8
    v_mfma_f32_16x16x32_bf16 v[212:215], a[48:51], a[12:15], v[212:215]
    s_add_u32 s73, s73, s74
    s_add_u32 s73, s73, 4718592
    v_lshlrev_b32 v7, 2, v3
    v_mfma_f32_16x16x32_bf16 v[216:219], a[48:51], a[32:35], v[216:219]
    v_add_u32 v87, s73, v7
    v_lshl_add_u32 v7, v2, 2, v4
    v_mul_u32_u24 v7, 288, v7
    s_waitcnt vmcnt(14) lgkmcnt(0)
    s_barrier
    s_cmp_eq_u32 s3, 0
    s_cbranch_scc0 .w0_6
    global_load_dword v88, v91, s[32:33]
.w0_6:
    v_mfma_f32_16x16x32_bf16 v[96:99], a[88:91], a[52:55], v[96:99]
    ds_read_b64_tr_b16 a[36:37], v43 offset:0
    v_lshl_add_u32 v7, v5, 3, v7
    s_lshr_b32 s72, s3, 1
    v_mfma_f32_16x16x32_bf16 v[100:103], a[88:91], a[56:59], v[100:103]
    ds_read_b64_tr_b16 a[38:39], v43 offset:432
    s_mul_i32 s72, s72, 55296
    s_add_u32 m0, s67, 18432
    v_mfma_f32_16x16x32_bf16 v[104:107], a[88:91], a[60:63], v[104:107]
    buffer_load_dwordx4 v10, s[36:39], s64 offen lds
    ds_read_b128 a[0:3], v36 offset:36864
    v_add_u32 v93, s72, v7
    v_mfma_f32_16x16x32_bf16 v[108:111], a[88:91], a[64:67], v[108:111]
    v_add_u32 v94, 41472, v93
    v_mfma_f32_16x16x32_bf16 v[112:115], a[88:91], a[68:71], v[112:115]
    ds_read_b128 a[4:7], v36 offset:38912
    s_add_u32 m0, s67, 22528
    v_mfma_f32_16x16x32_bf16 v[116:119], a[88:91], a[72:75], v[116:119]
    buffer_load_dwordx4 v11, s[36:39], s64 offen lds
    ds_read_b128 a[8:11], v36 offset:40960
    v_mfma_f32_16x16x32_bf16 v[120:123], a[88:91], a[76:79], v[120:123]
    v_mfma_f32_16x16x32_bf16 v[124:127], a[88:91], a[80:83], v[124:127]
    ds_read_b128 a[12:15], v36 offset:43008
    v_mfma_f32_16x16x32_bf16 v[128:131], a[92:95], a[52:55], v[128:131]
    ds_read_b128 a[16:19], v38 offset:36864
    s_add_u32 m0, s67, 26624
    v_mfma_f32_16x16x32_bf16 v[132:135], a[92:95], a[56:59], v[132:135]
    buffer_load_dwordx4 v12, s[36:39], s64 offen lds
    ds_read_b128 a[20:23], v38 offset:38912
    v_mfma_f32_16x16x32_bf16 v[136:139], a[92:95], a[60:63], v[136:139]
    v_mfma_f32_16x16x32_bf16 v[140:143], a[92:95], a[64:67], v[140:143]
    ds_read_b128 a[24:27], v38 offset:40960
    v_mfma_f32_16x16x32_bf16 v[144:147], a[92:95], a[68:71], v[144:147]
    ds_read_b128 a[28:31], v38 offset:43008
    s_add_u32 m0, s67, 30720
    v_mfma_f32_16x16x32_bf16 v[148:151], a[92:95], a[72:75], v[148:151]
    buffer_load_dwordx4 v13, s[36:39], s64 offen lds
    v_mfma_f32_16x16x32_bf16 v[152:155], a[92:95], a[76:79], v[152:155]
    ds_read_b64_tr_b16 a[40:41], v43 offset:144
    v_mfma_f32_16x16x32_bf16 v[156:159], a[92:95], a[80:83], v[156:159]
    ds_read_b64_tr_b16 a[42:43], v43 offset:576
    s_add_u32 m0, s67, 82944
    v_mfma_f32_16x16x32_bf16 v[192:195], a[92:95], a[84:87], v[192:195]
    buffer_load_dwordx4 v14, s[40:43], s65 offen lds
    ds_read_b128 a[32:35], v40 offset:36864
    v_mfma_f32_16x16x32_bf16 v[160:163], a[52:55], a[96:99], v[160:163]
    v_mfma_f32_16x16x32_bf16 v[164:167], a[56:59], a[96:99], v[164:167]
    ds_read_b64_tr_b16 a[44:45], v43 offset:288
    v_mfma_f32_16x16x32_bf16 v[168:171], a[60:63], a[96:99], v[168:171]
    ds_read_b64_tr_b16 a[46:47], v43 offset:720
    s_add_u32 m0, s67, 87040
    v_mfma_f32_16x16x32_bf16 v[172:175], a[64:67], a[96:99], v[172:175]
    buffer_load_dwordx4 v15, s[40:43], s65 offen lds
    v_mfma_f32_16x16x32_bf16 v[176:179], a[68:71], a[96:99], v[176:179]
    ds_read_b64_tr_b16 a[48:49], v44 offset:0
    v_mfma_f32_16x16x32_bf16 v[180:183], a[72:75], a[96:99], v[180:183]
    ds_read_b64_tr_b16 a[50:51], v45 offset:0
    v_mfma_f32_16x16x32_bf16 v[184:187], a[76:79], a[96:99], v[184:187]
    s_add_u32 m0, s67, 91136
    v_mfma_f32_16x16x32_bf16 v[188:191], a[80:83], a[96:99], v[188:191]
    buffer_load_dwordx4 v16, s[40:43], s65 offen lds
    v_mfma_f32_16x16x32_bf16 v[196:199], a[84:87], a[96:99], v[196:199]
    v_mfma_f32_16x16x32_bf16 v[200:203], a[100:103], a[52:55], v[200:203]
    s_add_u32 m0, s67, 95232
    v_mfma_f32_16x16x32_bf16 v[204:207], a[100:103], a[56:59], v[204:207]
    buffer_load_dwordx4 v17, s[40:43], s65 offen lds
    v_mfma_f32_16x16x32_bf16 v[208:211], a[100:103], a[60:63], v[208:211]
    v_mfma_f32_16x16x32_bf16 v[212:215], a[100:103], a[64:67], v[212:215]
    v_mfma_f32_16x16x32_bf16 v[216:219], a[100:103], a[84:87], v[216:219]
    s_waitcnt lgkmcnt(0)
    s_add_u32 m0, s67, 99328
    v_mfma_f32_16x16x32_bf16 v[96:99], a[36:39], a[0:3], v[96:99]
    buffer_load_dwordx4 v18, s[40:43], s65 offen lds
    ds_read_b64_tr_b16 a[88:89], v43 offset:13824
    v_mfma_f32_16x16x32_bf16 v[100:103], a[36:39], a[4:7], v[100:103]
    ds_read_b64_tr_b16 a[90:91], v43 offset:14256
    v_mfma_f32_16x16x32_bf16 v[104:107], a[36:39], a[8:11], v[104:107]
    ds_read_b128 a[52:55], v37 offset:36864
    v_mfma_f32_16x16x32_bf16 v[108:111], a[36:39], a[12:15], v[108:111]
    s_add_u32 m0, s67, 103424
    v_mfma_f32_16x16x32_bf16 v[112:115], a[36:39], a[16:19], v[112:115]
    buffer_load_dwordx4 v19, s[40:43], s65 offen lds
    ds_read_b128 a[56:59], v37 offset:38912
    v_mfma_f32_16x16x32_bf16 v[116:119], a[36:39], a[20:23], v[116:119]
    ds_read_b128 a[60:63], v37 offset:40960
    v_mfma_f32_16x16x32_bf16 v[120:123], a[36:39], a[24:27], v[120:123]
    s_mov_b32 m0, s69
    v_mfma_f32_16x16x32_bf16 v[124:127], a[36:39], a[28:31], v[124:127]
    buffer_load_dwordx4 v20, s[44:47], s66 offen lds
    ds_read_b128 a[64:67], v37 offset:43008
    v_mfma_f32_16x16x32_bf16 v[128:131], a[40:43], a[0:3], v[128:131]
    ds_read_b128 a[68:71], v39 offset:36864
    v_mfma_f32_16x16x32_bf16 v[132:135], a[40:43], a[4:7], v[132:135]
    ds_read_b128 a[72:75], v39 offset:38912
    v_mfma_f32_16x16x32_bf16 v[136:139], a[40:43], a[8:11], v[136:139]
    s_add_u32 m0, s71, 109568
    v_mfma_f32_16x16x32_bf16 v[140:143], a[40:43], a[12:15], v[140:143]
    buffer_load_dword v21, s[40:43], s65 offen lds
    ds_read_b128 a[76:79], v39 offset:40960
    v_mfma_f32_16x16x32_bf16 v[144:147], a[40:43], a[16:19], v[144:147]
    ds_read_b128 a[80:83], v39 offset:43008
    s_add_u32 s64, s64, 128
    v_mfma_f32_16x16x32_bf16 v[148:151], a[40:43], a[20:23], v[148:151]
    s_add_u32 s65, s65, 221184
    v_mfma_f32_16x16x32_bf16 v[152:155], a[40:43], a[24:27], v[152:155]
    ds_read_b64_tr_b16 a[92:93], v43 offset:13968
    v_mfma_f32_16x16x32_bf16 v[156:159], a[40:43], a[28:31], v[156:159]
    ds_read_b64_tr_b16 a[94:95], v43 offset:14400
    s_add_u32 s11, s11, 1
    v_mfma_f32_16x16x32_bf16 v[192:195], a[40:43], a[32:35], v[192:195]
    ds_read_b128 a[84:87], v41 offset:36864
    v_mfma_f32_16x16x32_bf16 v[160:163], a[0:3], a[44:47], v[160:163]
    s_cmp_eq_u32 s11, 9
    s_cselect_b32 s11, 0, s11
    s_cselect_b32 s64, 0, s64
    s_cselect_b32 s65, 0, s65
    v_mfma_f32_16x16x32_bf16 v[164:167], a[4:7], a[44:47], v[164:167]
    ds_read_b64_tr_b16 a[96:97], v43 offset:14112
    v_mfma_f32_16x16x32_bf16 v[168:171], a[8:11], a[44:47], v[168:171]
    ds_read_b64_tr_b16 a[98:99], v43 offset:14544
    s_cmp_lt_u32 s3, 2
    s_cselect_b32 s66, s64, s65
    v_mfma_f32_16x16x32_bf16 v[172:175], a[12:15], a[44:47], v[172:175]
    v_mfma_f32_16x16x32_bf16 v[176:179], a[16:19], a[44:47], v[176:179]
    ds_read_b64_tr_b16 a[100:101], v46 offset:0
    v_mfma_f32_16x16x32_bf16 v[180:183], a[20:23], a[44:47], v[180:183]
    ds_read_b64_tr_b16 a[102:103], v47 offset:0
    v_mfma_f32_16x16x32_bf16 v[184:187], a[24:27], a[44:47], v[184:187]
    v_mfma_f32_16x16x32_bf16 v[188:191], a[28:31], a[44:47], v[188:191]
    v_add_u32 v44, v49, v44
    v_mfma_f32_16x16x32_bf16 v[196:199], a[32:35], a[44:47], v[196:199]
    v_add_u32 v45, v49, v45
    v_mfma_f32_16x16x32_bf16 v[200:203], a[48:51], a[0:3], v[200:203]
    v_add_u32 v46, v49, v46
    v_mfma_f32_16x16x32_bf16 v[204:207], a[48:51], a[4:7], v[204:207]
    v_add_u32 v47, v49, v47
    v_mfma_f32_16x16x32_bf16 v[208:211], a[48:51], a[8:11], v[208:211]
    v_mfma_f32_16x16x32_bf16 v[212:215], a[48:51], a[12:15], v[212:215]
    v_mfma_f32_16x16x32_bf16 v[216:219], a[48:51], a[32:35], v[216:219]
    s_waitcnt vmcnt(12) lgkmcnt(0)
    s_barrier
    s_cmp_eq_u32 s3, 0
    s_cbranch_scc0 .w0_7
    v_readfirstlane_b32 s76, v88
    s_nop 0
    s_cmp_eq_u32 s76, s10
    s_cbranch_scc0 .w0_7
    s_mov_b32 s12, 1
    s_mov_b64 exec, 1
    global_atomic_add v253, v89, v92, s[34:35] sc0
    s_mov_b64 exec, -1
.w0_7:
    v_mfma_f32_16x16x32_bf16 v[96:99], a[88:91], a[52:55], v[96:99]
    ds_read_b64_tr_b16 a[36:37], v42 offset:0
    v_mfma_f32_16x16x32_bf16 v[100:103], a[88:91], a[56:59], v[100:103]
    ds_read_b64_tr_b16 a[38:39], v42 offset:432
    s_add_u32 m0, s67, 36864
    v_mfma_f32_16x16x32_bf16 v[104:107], a[88:91], a[60:63], v[104:107]
    buffer_load_dwordx4 v10, s[36:39], s64 offen lds
    ds_read_b128 a[0:3], v36 offset:0
    v_mfma_f32_16x16x32_bf16 v[108:111], a[88:91], a[64:67], v[108:111]
    v_mfma_f32_16x16x32_bf16 v[112:115], a[88:91], a[68:71], v[112:115]
    ds_read_b128 a[4:7], v36 offset:2048
    s_add_u32 m0, s67, 40960
    v_mfma_f32_16x16x32_bf16 v[116:119], a[88:91], a[72:75], v[116:119]
    buffer_load_dwordx4 v11, s[36:39], s64 offen lds
    ds_read_b128 a[8:11], v36 offset:4096
    v_mfma_f32_16x16x32_bf16 v[120:123], a[88:91], a[76:79], v[120:123]
    v_mfma_f32_16x16x32_bf16 v[124:127], a[88:91], a[80:83], v[124:127]
    ds_read_b128 a[12:15], v36 offset:6144
    v_mfma_f32_16x16x32_bf16 v[128:131], a[92:95], a[52:55], v[128:131]
    ds_read_b128 a[16:19], v38 offset:0
    s_add_u32 m0, s67, 45056
    v_mfma_f32_16x16x32_bf16 v[132:135], a[92:95], a[56:59], v[132:135]
    buffer_load_dwordx4 v12, s[36:39], s64 offen lds
    ds_read_b128 a[20:23], v38 offset:2048
    v_mfma_f32_16x16x32_bf16 v[136:139], a[92:95], a[60:63], v[136:139]
    v_mfma_f32_16x16x32_bf16 v[140:143], a[92:95], a[64:67], v[140:143]
    ds_read_b128 a[24:27], v38 offset:4096
    v_mfma_f32_16x16x32_bf16 v[144:147], a[92:95], a[68:71], v[144:147]
    ds_read_b128 a[28:31], v38 offset:6144
    s_add_u32 m0, s67, 49152
    v_mfma_f32_16x16x32_bf16 v[148:151], a[92:95], a[72:75], v[148:151]
    buffer_load_dwordx4 v13, s[36:39], s64 offen lds
    v_mfma_f32_16x16x32_bf16 v[152:155], a[92:95], a[76:79], v[152:155]
    ds_read_b64_tr_b16 a[40:41], v42 offset:144
    v_mfma_f32_16x16x32_bf16 v[156:159], a[92:95], a[80:83], v[156:159]
    ds_read_b64_tr_b16 a[42:43], v42 offset:576
    s_add_u32 m0, s67, 110592
    v_mfma_f32_16x16x32_bf16 v[192:195], a[92:95], a[84:87], v[192:195]
    buffer_load_dwordx4 v14, s[40:43], s65 offen lds
    ds_read_b128 a[32:35], v40 offset:0
    v_mfma_f32_16x16x32_bf16 v[160:163], a[52:55], a[96:99], v[160:163]
    v_mfma_f32_16x16x32_bf16 v[164:167], a[56:59], a[96:99], v[164:167]
    ds_read_b64_tr_b16 a[44:45], v42 offset:288
    v_mfma_f32_16x16x32_bf16 v[168:171], a[60:63], a[96:99], v[168:171]
    ds_read_b64_tr_b16 a[46:47], v42 offset:720
    s_add_u32 m0, s67, 114688
    v_mfma_f32_16x16x32_bf16 v[172:175], a[64:67], a[96:99], v[172:175]
    buffer_load_dwordx4 v15, s[40:43], s65 offen lds
    v_mfma_f32_16x16x32_bf16 v[176:179], a[68:71], a[96:99], v[176:179]
    ds_read_b64_tr_b16 a[48:49], v44 offset:0
    v_mfma_f32_16x16x32_bf16 v[180:183], a[72:75], a[96:99], v[180:183]
    ds_read_b64_tr_b16 a[50:51], v45 offset:0
    v_mfma_f32_16x16x32_bf16 v[184:187], a[76:79], a[96:99], v[184:187]
    s_add_u32 m0, s67, 118784
    v_mfma_f32_16x16x32_bf16 v[188:191], a[80:83], a[96:99], v[188:191]
    buffer_load_dwordx4 v16, s[40:43], s65 offen lds
    v_mfma_f32_16x16x32_bf16 v[196:199], a[84:87], a[96:99], v[196:199]
    v_mfma_f32_16x16x32_bf16 v[200:203], a[100:103], a[52:55], v[200:203]
    s_add_u32 m0, s67, 122880
    v_mfma_f32_16x16x32_bf16 v[204:207], a[100:103], a[56:59], v[204:207]
    buffer_load_dwordx4 v17, s[40:43], s65 offen lds
    v_mfma_f32_16x16x32_bf16 v[208:211], a[100:103], a[60:63], v[208:211]
    v_mfma_f32_16x16x32_bf16 v[212:215], a[100:103], a[64:67], v[212:215]
    v_mfma_f32_16x16x32_bf16 v[216:219], a[100:103], a[84:87], v[216:219]
    s_waitcnt lgkmcnt(0)
    s_add_u32 m0, s67, 126976
    v_mfma_f32_16x16x32_bf16 v[96:99], a[36:39], a[0:3], v[96:99]
    buffer_load_dwordx4 v18, s[40:43], s65 offen lds
    ds_read_b64_tr_b16 a[88:89], v42 offset:13824
    v_mfma_f32_16x16x32_bf16 v[100:103], a[36:39], a[4:7], v[100:103]
    ds_read_b64_tr_b16 a[90:91], v42 offset:14256
    v_mfma_f32_16x16x32_bf16 v[104:107], a[36:39], a[8:11], v[104:107]
    ds_read_b128 a[52:55], v37 offset:0
    v_mfma_f32_16x16x32_bf16 v[108:111], a[36:39], a[12:15], v[108:111]
    s_add_u32 m0, s67, 131072
    v_mfma_f32_16x16x32_bf16 v[112:115], a[36:39], a[16:19], v[112:115]
    buffer_load_dwordx4 v19, s[40:43], s65 offen lds
    ds_read_b128 a[56:59], v37 offset:2048
    v_mfma_f32_16x16x32_bf16 v[116:119], a[36:39], a[20:23], v[116:119]
    ds_read_b128 a[60:63], v37 offset:4096
    v_mfma_f32_16x16x32_bf16 v[120:123], a[36:39], a[24:27], v[120:123]
    s_mov_b32 m0, s70
    v_mfma_f32_16x16x32_bf16 v[124:127], a[36:39], a[28:31], v[124:127]
    buffer_load_dwordx4 v20, s[44:47], s66 offen lds
    ds_read_b128 a[64:67], v37 offset:6144
    v_mfma_f32_16x16x32_bf16 v[128:131], a[40:43], a[0:3], v[128:131]
    ds_read_b128 a[68:71], v39 offset:0
    v_mfma_f32_16x16x32_bf16 v[132:135], a[40:43], a[4:7], v[132:135]
    ds_read_b128 a[72:75], v39 offset:2048
    v_mfma_f32_16x16x32_bf16 v[136:139], a[40:43], a[8:11], v[136:139]
    s_add_u32 m0, s71, 137216
    v_mfma_f32_16x16x32_bf16 v[140:143], a[40:43], a[12:15], v[140:143]
    buffer_load_dword v21, s[40:43], s65 offen lds
    ds_read_b128 a[76:79], v39 offset:4096
    v_mfma_f32_16x16x32_bf16 v[144:147], a[40:43], a[16:19], v[144:147]
    ds_read_b128 a[80:83], v39 offset:6144
    s_add_u32 s64, s64, 128
    v_mfma_f32_16x16x32_bf16 v[148:151], a[40:43], a[20:23], v[148:151]
    s_add_u32 s65, s65, 221184
    v_mfma_f32_16x16x32_bf16 v[152:155], a[40:43], a[24:27], v[152:155]
    ds_read_b64_tr_b16 a[92:93], v42 offset:13968
    v_mfma_f32_16x16x32_bf16 v[156:159], a[40:43], a[28:31], v[156:159]
    ds_read_b64_tr_b16 a[94:95], v42 offset:14400
    s_add_u32 s11, s11, 1
    v_mfma_f32_16x16x32_bf16 v[192:195], a[40:43], a[32:35], v[192:195]
    ds_read_b128 a[84:87], v41 offset:0
    v_mfma_f32_16x16x32_bf16 v[160:163], a[0:3], a[44:47], v[160:163]
    s_cmp_eq_u32 s11, 9
    s_cselect_b32 s11, 0, s11
    s_cselect_b32 s64, 0, s64
    s_cselect_b32 s65, 0, s65
    v_mfma_f32_16x16x32_bf16 v[164:167], a[4:7], a[44:47], v[164:167]
    ds_read_b64_tr_b16 a[96:97], v42 offset:14112
    v_mfma_f32_16x16x32_bf16 v[168:171], a[8:11], a[44:47], v[168:171]
    ds_read_b64_tr_b16 a[98:99], v42 offset:14544
    s_cmp_lt_u32 s3, 2
    s_cselect_b32 s66, s64, s65
    v_mfma_f32_16x16x32_bf16 v[172:175], a[12:15], a[44:47], v[172:175]
    v_mfma_f32_16x16x32_bf16 v[176:179], a[16:19], a[44:47], v[176:179]
    ds_read_b64_tr_b16 a[100:101], v46 offset:0
    v_mfma_f32_16x16x32_bf16 v[180:183], a[20:23], a[44:47], v[180:183]
    ds_read_b64_tr_b16 a[102:103], v47 offset:0
    v_mfma_f32_16x16x32_bf16 v[184:187], a[24:27], a[44:47], v[184:187]
    v_mfma_f32_16x16x32_bf16 v[188:191], a[28:31], a[44:47], v[188:191]
    v_add_u32 v44, v48, v44
    v_mfma_f32_16x16x32_bf16 v[196:199], a[32:35], a[44:47], v[196:199]
    v_add_u32 v45, v48, v45
    v_mfma_f32_16x16x32_bf16 v[200:203], a[48:51], a[0:3], v[200:203]
    v_add_u32 v46, v48, v46
    v_mfma_f32_16x16x32_bf16 v[204:207], a[48:51], a[4:7], v[204:207]
    v_add_u32 v47, v48, v47
    v_mfma_f32_16x16x32_bf16 v[208:211], a[48:51], a[8:11], v[208:211]
    v_mfma_f32_16x16x32_bf16 v[212:215], a[48:51], a[12:15], v[212:215]
    v_mfma_f32_16x16x32_bf16 v[216:219], a[48:51], a[32:35], v[216:219]
    s_waitcnt vmcnt(12) lgkmcnt(0)
    s_barrier
    s_cmp_eq_u32 s3, 0
    s_cbranch_scc0 .w0_8
    v_readfirstlane_b32 s76, v253
    s_nop 0
    s_cmp_eq_u32 s76, 31
    s_cbranch_scc0 .w0_8
    s_mov_b64 exec, 1
    global_atomic_add v250, v92, s[32:33] sc1
    s_mov_b64 exec, -1
.w0_8:
    s_cmp_eq_u32 s3, 0
    s_cbranch_scc0 .w0_9
    s_cmp_eq_u32 s12, 0
    s_cbranch_scc0 .w0_9
    global_load_dword v88, v91, s[32:33] sc1
.w0_9:
    v_mfma_f32_16x16x32_bf16 v[96:99], a[88:91], a[52:55], v[96:99]
    ds_read_b64_tr_b16 a[36:37], v42 offset:27648
    v_mfma_f32_16x16x32_bf16 v[100:103], a[88:91], a[56:59], v[100:103]
    ds_read_b64_tr_b16 a[38:39], v42 offset:28080
    s_add_u32 m0, s67, 0
    v_mfma_f32_16x16x32_bf16 v[104:107], a[88:91], a[60:63], v[104:107]
    buffer_load_dwordx4 v10, s[36:39], s64 offen lds
    ds_read_b128 a[0:3], v36 offset:18432
    v_mfma_f32_16x16x32_bf16 v[108:111], a[88:91], a[64:67], v[108:111]
    v_mfma_f32_16x16x32_bf16 v[112:115], a[88:91], a[68:71], v[112:115]
    ds_read_b128 a[4:7], v36 offset:20480
    s_add_u32 m0, s67, 4096
    v_mfma_f32_16x16x32_bf16 v[116:119], a[88:91], a[72:75], v[116:119]
    buffer_load_dwordx4 v11, s[36:39], s64 offen lds
    ds_read_b128 a[8:11], v36 offset:22528
    v_mfma_f32_16x16x32_bf16 v[120:123], a[88:91], a[76:79], v[120:123]
    v_mfma_f32_16x16x32_bf16 v[124:127], a[88:91], a[80:83], v[124:127]
    ds_read_b128 a[12:15], v36 offset:24576
    v_mfma_f32_16x16x32_bf16 v[128:131], a[92:95], a[52:55], v[128:131]
    ds_read_b128 a[16:19], v38 offset:18432
    s_add_u32 m0, s67, 8192
    v_mfma_f32_16x16x32_bf16 v[132:135], a[92:95], a[56:59], v[132:135]
    buffer_load_dwordx4 v12, s[36:39], s64 offen lds
    ds_read_b128 a[20:23], v38 offset:20480
    v_mfma_f32_16x16x32_bf16 v[136:139], a[92:95], a[60:63], v[136:139]
    s_branch .Lsk2
.Lpad2:
    s_branch .Lpad5
.Lsk2:
    v_mfma_f32_16x16x32_bf16 v[140:143], a[92:95], a[64:67], v[140:143]
    ds_read_b128 a[24:27], v38 offset:22528
    v_mfma_f32_16x16x32_bf16 v[144:147], a[92:95], a[68:71], v[144:147]
    ds_read_b128 a[28:31], v38 offset:24576
    s_add_u32 m0, s67, 12288
    v_mfma_f32_16x16x32_bf16 v[148:151], a[92:95], a[72:75], v[148:151]
    buffer_load_dwordx4 v13, s[36:39], s64 offen lds
    v_mfma_f32_16x16x32_bf16 v[152:155], a[92:95], a[76:79], v[152:155]
    ds_read_b64_tr_b16 a[40:41], v42 offset:27792
    v_mfma_f32_16x16x32_bf16 v[156:159], a[92:95], a[80:83], v[156:159]
    ds_read_b64_tr_b16 a[42:43], v42 offset:28224
    s_add_u32 m0, s67, 55296
    v_mfma_f32_16x16x32_bf16 v[192:195], a[92:95], a[84:87], v[192:195]
    buffer_load_dwordx4 v14, s[40:43], s65 offen lds
    ds_read_b128 a[32:35], v40 offset:18432
    v_mfma_f32_16x16x32_bf16 v[160:163], a[52:55], a[96:99], v[160:163]
    v_mfma_f32_16x16x32_bf16 v[164:167], a[56:59], a[96:99], v[164:167]
    ds_read_b64_tr_b16 a[44:45], v42 offset:27936
    v_mfma_f32_16x16x32_bf16 v[168:171], a[60:63], a[96:99], v[168:171]
    ds_read_b64_tr_b16 a[46:47], v42 offset:28368
    s_add_u32 m0, s67, 59392
    v_mfma_f32_16x16x32_bf16 v[172:175], a[64:67], a[96:99], v[172:175]
    buffer_load_dwordx4 v15, s[40:43], s65 offen lds
    v_mfma_f32_16x16x32_bf16 v[176:179], a[68:71], a[96:99], v[176:179]
    ds_read_b64_tr_b16 a[48:49], v44 offset:0
    v_mfma_f32_16x16x32_bf16 v[180:183], a[72:75], a[96:99], v[180:183]
    ds_read_b64_tr_b16 a[50:51], v45 offset:0
    v_mfma_f32_16x16x32_bf16 v[184:187], a[76:79], a[96:99], v[184:187]
    s_add_u32 m0, s67, 63488
    v_mfma_f32_16x16x32_bf16 v[188:191], a[80:83], a[96:99], v[188:191]
    buffer_load_dwordx4 v16, s[40:43], s65 offen lds
    v_mfma_f32_16x16x32_bf16 v[196:199], a[84:87], a[96:99], v[196:199]
    v_mfma_f32_16x16x32_bf16 v[200:203], a[100:103], a[52:55], v[200:203]
    s_add_u32 m0, s67, 67584
    v_mfma_f32_16x16x32_bf16 v[204:207], a[100:103], a[56:59], v[204:207]
    buffer_load_dwordx4 v17, s[40:43], s65 offen lds
    v_mfma_f32_16x16x32_bf16 v[208:211], a[100:103], a[60:63], v[208:211]
    v_mfma_f32_16x16x32_bf16 v[212:215], a[100:103], a[64:67], v[212:215]
    v_mfma_f32_16x16x32_bf16 v[216:219], a[100:103], a[84:87], v[216:219]
    s_waitcnt lgkmcnt(0)
    s_add_u32 m0, s67, 71680
    v_mfma_f32_16x16x32_bf16 v[96:99], a[36:39], a[0:3], v[96:99]
    buffer_load_dwordx4 v18, s[40:43], s65 offen lds
    ds_read_b64_tr_b16 a[88:89], v42 offset:41472
    v_mfma_f32_16x16x32_bf16 v[100:103], a[36:39], a[4:7], v[100:103]
    ds_read_b64_tr_b16 a[90:91], v42 offset:41904
    v_mfma_f32_16x16x32_bf16 v[104:107], a[36:39], a[8:11], v[104:107]
    ds_read_b128 a[52:55], v37 offset:18432
    v_mfma_f32_16x16x32_bf16 v[108:111], a[36:39], a[12:15], v[108:111]
    s_add_u32 m0, s67, 75776
    v_mfma_f32_16x16x32_bf16 v[112:115], a[36:39], a[16:19], v[112:115]
    buffer_load_dwordx4 v19, s[40:43], s65 offen lds
    ds_read_b128 a[56:59], v37 offset:20480
    v_mfma_f32_16x16x32_bf16 v[116:119], a[36:39], a[20:23], v[116:119]
    ds_read_b128 a[60:63], v37 offset:22528
    v_mfma_f32_16x16x32_bf16 v[120:123], a[36:39], a[24:27], v[120:123]
    s_mov_b32 m0, s68
    v_mfma_f32_16x16x32_bf16 v[124:127], a[36:39], a[28:31], v[124:127]
    buffer_load_dwordx4 v20, s[44:47], s66 offen lds
    ds_read_b128 a[64:67], v37 offset:24576
    v_mfma_f32_16x16x32_bf16 v[128:131], a[40:43], a[0:3], v[128:131]
    ds_read_b128 a[68:71], v39 offset:18432
    v_mfma_f32_16x16x32_bf16 v[132:135], a[40:43], a[4:7], v[132:135]
    ds_read_b128 a[72:75], v39 offset:20480
    v_mfma_f32_16x16x32_bf16 v[136:139], a[40:43], a[8:11], v[136:139]
    s_add_u32 m0, s71, 81920
    v_mfma_f32_16x16x32_bf16 v[140:143], a[40:43], a[12:15], v[140:143]
    buffer_load_dword v21, s[40:43], s65 offen lds
    ds_read_b128 a[76:79], v39 offset:22528
    v_mfma_f32_16x16x32_bf16 v[144:147], a[40:43], a[16:19], v[144:147]
    ds_read_b128 a[80:83], v39 offset:24576
    s_add_u32 s64, s64, 128
    v_mfma_f32_16x16x32_bf16 v[148:151], a[40:43], a[20:23], v[148:151]
    s_add_u32 s65, s65, 221184
    v_mfma_f32_16x16x32_bf16 v[152:155], a[40:43], a[24:27], v[152:155]
    ds_read_b64_tr_b16 a[92:93], v42 offset:41616
    v_mfma_f32_16x16x32_bf16 v[156:159], a[40:43], a[28:31], v[156:159]
    ds_read_b64_tr_b16 a[94:95], v42 offset:42048
    s_add_u32 s11, s11, 1
    v_mfma_f32_16x16x32_bf16 v[192:195], a[40:43], a[32:35], v[192:195]
    ds_read_b128 a[84:87], v41 offset:18432
    v_mfma_f32_16x16x32_bf16 v[160:163], a[0:3], a[44:47], v[160:163]
    s_cmp_eq_u32 s11, 9
    s_cselect_b32 s11, 0, s11
    s_cselect_b32 s64, 0, s64
    s_cselect_b32 s65, 0, s65
    v_mfma_f32_16x16x32_bf16 v[164:167], a[4:7], a[44:47], v[164:167]
    ds_read_b64_tr_b16 a[96:97], v42 offset:41760
    v_mfma_f32_16x16x32_bf16 v[168:171], a[8:11], a[44:47], v[168:171]
    ds_read_b64_tr_b16 a[98:99], v42 offset:42192
    s_cmp_lt_u32 s3, 2
    s_cselect_b32 s66, s64, s65
    v_mfma_f32_16x16x32_bf16 v[172:175], a[12:15], a[44:47], v[172:175]
    v_mfma_f32_16x16x32_bf16 v[176:179], a[16:19], a[44:47], v[176:179]
    ds_read_b64_tr_b16 a[100:101], v46 offset:0
    v_mfma_f32_16x16x32_bf16 v[180:183], a[20:23], a[44:47], v[180:183]
    ds_read_b64_tr_b16 a[102:103], v47 offset:0
    v_mfma_f32_16x16x32_bf16 v[184:187], a[24:27], a[44:47], v[184:187]
    v_mfma_f32_16x16x32_bf16 v[188:191], a[28:31], a[44:47], v[188:191]
    v_add_u32 v44, v48, v44
    v_mfma_f32_16x16x32_bf16 v[196:199], a[32:35], a[44:47], v[196:199]
    v_add_u32 v45, v48, v45
    v_mfma_f32_16x16x32_bf16 v[200:203], a[48:51], a[0:3], v[200:203]
    v_add_u32 v46, v48, v46
    v_mfma_f32_16x16x32_bf16 v[204:207], a[48:51], a[4:7], v[204:207]
    v_add_u32 v47, v48, v47
    v_mfma_f32_16x16x32_bf16 v[208:211], a[48:51], a[8:11], v[208:211]
    v_mfma_f32_16x16x32_bf16 v[212:215], a[48:51], a[12:15], v[212:215]
    v_mfma_f32_16x16x32_bf16 v[216:219], a[48:51], a[32:35], v[216:219]
    s_waitcnt vmcnt(12) lgkmcnt(0)
    s_barrier
    s_cmp_eq_u32 s3, 0
    s_cbranch_scc0 .w0_10
    s_cmp_eq_u32 s12, 0
    s_cbranch_scc0 .w0_10
    v_readfirstlane_b32 s76, v88
    s_nop 0
    s_cmp_eq_u32 s76, s10
    s_cbranch_scc0 .w0_10
    s_mov_b32 s12, 1
    s_mov_b64 exec, 1
    global_atomic_add v253, v89, v92, s[34:35] sc0
    s_mov_b64 exec, -1
.w0_10:
    v_mfma_f32_16x16x32_bf16 v[96:99], a[88:91], a[52:55], v[96:99]
    ds_read_b64_tr_b16 a[36:37], v43 offset:0
    v_mfma_f32_16x16x32_bf16 v[100:103], a[88:91], a[56:59], v[100:103]
    ds_read_b64_tr_b16 a[38:39], v43 offset:432
    s_add_u32 m0, s67, 18432
    v_mfma_f32_16x16x32_bf16 v[104:107], a[88:91], a[60:63], v[104:107]
    buffer_load_dwordx4 v10, s[36:39], s64 offen lds
    ds_read_b128 a[0:3], v36 offset:36864
    v_mfma_f32_16x16x32_bf16 v[108:111], a[88:91], a[64:67], v[108:111]
    v_mfma_f32_16x16x32_bf16 v[112:115], a[88:91], a[68:71], v[112:115]
    ds_read_b128 a[4:7], v36 offset:38912
    s_add_u32 m0, s67, 22528
    v_mfma_f32_16x16x32_bf16 v[116:119], a[88:91], a[72:75], v[116:119]
    buffer_load_dwordx4 v11, s[36:39], s64 offen lds
    ds_read_b128 a[8:11], v36 offset:40960
    v_mfma_f32_16x16x32_bf16 v[120:123], a[88:91], a[76:79], v[120:123]
    v_mfma_f32_16x16x32_bf16 v[124:127], a[88:91], a[80:83], v[124:127]
    ds_read_b128 a[12:15], v36 offset:43008
    v_mfma_f32_16x16x32_bf16 v[128:131], a[92:95], a[52:55], v[128:131]
    ds_read_b128 a[16:19], v38 offset:36864
    s_add_u32 m0, s67, 26624
    v_mfma_f32_16x16x32_bf16 v[132:135], a[92:95], a[56:59], v[132:135]
    buffer_load_dwordx4 v12, s[36:39], s64 offen lds
    ds_read_b128 a[20:23], v38 offset:38912
    v_mfma_f32_16x16x32_bf16 v[136:139], a[92:95], a[60:63], v[136:139]
    v_mfma_f32_16x16x32_bf16 v[140:143], a[92:95], a[64:67], v[140:143]
    ds_read_b128 a[24:27], v38 offset:40960
    v_mfma_f32_16x16x32_bf16 v[144:147], a[92:95], a[68:71], v[144:147]
    ds_read_b128 a[28:31], v38 offset:43008
    s_add_u32 m0, s67, 30720
    v_mfma_f32_16x16x32_bf16 v[148:151], a[92:95], a[72:75], v[148:151]
    buffer_load_dwordx4 v13, s[36:39], s64 offen lds
    v_mfma_f32_16x16x32_bf16 v[152:155], a[92:95], a[76:79], v[152:155]
    ds_read_b64_tr_b16 a[40:41], v43 offset:144
    v_mfma_f32_16x16x32_bf16 v[156:159], a[92:95], a[80:83], v[156:159]
    ds_read_b64_tr_b16 a[42:43], v43 offset:576
    s_add_u32 m0, s67, 82944
    v_mfma_f32_16x16x32_bf16 v[192:195], a[92:95], a[84:87], v[192:195]
    buffer_load_dwordx4 v14, s[40:43], s65 offen lds
    ds_read_b128 a[32:35], v40 offset:36864
    v_mfma_f32_16x16x32_bf16 v[160:163], a[52:55], a[96:99], v[160:163]
    v_mfma_f32_16x16x32_bf16 v[164:167], a[56:59], a[96:99], v[164:167]
    ds_read_b64_tr_b16 a[44:45], v43 offset:288
    v_mfma_f32_16x16x32_bf16 v[168:171], a[60:63], a[96:99], v[168:171]
    ds_read_b64_tr_b16 a[46:47], v43 offset:720
    s_add_u32 m0, s67, 87040
    v_mfma_f32_16x16x32_bf16 v[172:175], a[64:67], a[96:99], v[172:175]
    buffer_load_dwordx4 v15, s[40:43], s65 offen lds
    v_mfma_f32_16x16x32_bf16 v[176:179], a[68:71], a[96:99], v[176:179]
    ds_read_b64_tr_b16 a[48:49], v44 offset:0
    v_mfma_f32_16x16x32_bf16 v[180:183], a[72:75], a[96:99], v[180:183]
    ds_read_b64_tr_b16 a[50:51], v45 offset:0
    v_mfma_f32_16x16x32_bf16 v[184:187], a[76:79], a[96:99], v[184:187]
    s_add_u32 m0, s67, 91136
    v_mfma_f32_16x16x32_bf16 v[188:191], a[80:83], a[96:99], v[188:191]
    buffer_load_dwordx4 v16, s[40:43], s65 offen lds
    v_mfma_f32_16x16x32_bf16 v[196:199], a[84:87], a[96:99], v[196:199]
    v_mfma_f32_16x16x32_bf16 v[200:203], a[100:103], a[52:55], v[200:203]
    s_add_u32 m0, s67, 95232
    v_mfma_f32_16x16x32_bf16 v[204:207], a[100:103], a[56:59], v[204:207]
    buffer_load_dwordx4 v17, s[40:43], s65 offen lds
    v_mfma_f32_16x16x32_bf16 v[208:211], a[100:103], a[60:63], v[208:211]
    v_mfma_f32_16x16x32_bf16 v[212:215], a[100:103], a[64:67], v[212:215]
    v_mfma_f32_16x16x32_bf16 v[216:219], a[100:103], a[84:87], v[216:219]
    s_waitcnt lgkmcnt(0)
    s_add_u32 m0, s67, 99328
    v_mfma_f32_16x16x32_bf16 v[96:99], a[36:39], a[0:3], v[96:99]
    buffer_load_dwordx4 v18, s[40:43], s65 offen lds
    ds_read_b64_tr_b16 a[88:89], v43 offset:13824
    v_mfma_f32_16x16x32_bf16 v[100:103], a[36:39], a[4:7], v[100:103]
    ds_read_b64_tr_b16 a[90:91], v43 offset:14256
    v_mfma_f32_16x16x32_bf16 v[104:107], a[36:39], a[8:11], v[104:107]
    ds_read_b128 a[52:55], v37 offset:36864
    v_mfma_f32_16x16x32_bf16 v[108:111], a[36:39], a[12:15], v[108:111]
    s_add_u32 m0, s67, 103424
    v_mfma_f32_16x16x32_bf16 v[112:115], a[36:39], a[16:19], v[112:115]
    buffer_load_dwordx4 v19, s[40:43], s65 offen lds
    ds_read_b128 a[56:59], v37 offset:38912
    v_mfma_f32_16x16x32_bf16 v[116:119], a[36:39], a[20:23], v[116:119]
    ds_read_b128 a[60:63], v37 offset:40960
    v_mfma_f32_16x16x32_bf16 v[120:123], a[36:39], a[24:27], v[120:123]
    s_mov_b32 m0, s69
    v_mfma_f32_16x16x32_bf16 v[124:127], a[36:39], a[28:31], v[124:127]
    buffer_load_dwordx4 v20, s[44:47], s66 offen lds
    ds_read_b128 a[64:67], v37 offset:43008
    v_mfma_f32_16x16x32_bf16 v[128:131], a[40:43], a[0:3], v[128:131]
    ds_read_b128 a[68:71], v39 offset:36864
    v_mfma_f32_16x16x32_bf16 v[132:135], a[40:43], a[4:7], v[132:135]
    ds_read_b128 a[72:75], v39 offset:38912
    v_mfma_f32_16x16x32_bf16 v[136:139], a[40:43], a[8:11], v[136:139]
    s_add_u32 m0, s71, 109568
    v_mfma_f32_16x16x32_bf16 v[140:143], a[40:43], a[12:15], v[140:143]
    buffer_load_dword v21, s[40:43], s65 offen lds
    ds_read_b128 a[76:79], v39 offset:40960
    v_mfma_f32_16x16x32_bf16 v[144:147], a[40:43], a[16:19], v[144:147]
    ds_read_b128 a[80:83], v39 offset:43008
    s_add_u32 s64, s64, 128
    v_mfma_f32_16x16x32_bf16 v[148:151], a[40:43], a[20:23], v[148:151]
    s_add_u32 s65, s65, 221184
    v_mfma_f32_16x16x32_bf16 v[152:155], a[40:43], a[24:27], v[152:155]
    ds_read_b64_tr_b16 a[92:93], v43 offset:13968
    v_mfma_f32_16x16x32_bf16 v[156:159], a[40:43], a[28:31], v[156:159]
    ds_read_b64_tr_b16 a[94:95], v43 offset:14400
    s_add_u32 s11, s11, 1
    v_mfma_f32_16x16x32_bf16 v[192:195], a[40:43], a[32:35], v[192:195]
    ds_read_b128 a[84:87], v41 offset:36864
    v_mfma_f32_16x16x32_bf16 v[160:163], a[0:3], a[44:47], v[160:163]
    s_cmp_eq_u32 s11, 9
    s_cselect_b32 s11, 0, s11
    s_cselect_b32 s64, 0, s64
    s_cselect_b32 s65, 0, s65
    v_mfma_f32_16x16x32_bf16 v[164:167], a[4:7], a[44:47], v[164:167]
    ds_read_b64_tr_b16 a[96:97], v43 offset:14112
    v_mfma_f32_16x16x32_bf16 v[168:171], a[8:11], a[44:47], v[168:171]
    ds_read_b64_tr_b16 a[98:99], v43 offset:14544
    s_cmp_lt_u32 s3, 2
    s_cselect_b32 s66, s64, s65
    v_mfma_f32_16x16x32_bf16 v[172:175], a[12:15], a[44:47], v[172:175]
    v_mfma_f32_16x16x32_bf16 v[176:179], a[16:19], a[44:47], v[176:179]
    ds_read_b64_tr_b16 a[100:101], v46 offset:0
    v_mfma_f32_16x16x32_bf16 v[180:183], a[20:23], a[44:47], v[180:183]
    ds_read_b64_tr_b16 a[102:103], v47 offset:0
    v_mfma_f32_16x16x32_bf16 v[184:187], a[24:27], a[44:47], v[184:187]
    v_mfma_f32_16x16x32_bf16 v[188:191], a[28:31], a[44:47], v[188:191]
    v_add_u32 v44, v49, v44
    v_mfma_f32_16x16x32_bf16 v[196:199], a[32:35], a[44:47], v[196:199]
    v_add_u32 v45, v49, v45
    v_mfma_f32_16x16x32_bf16 v[200:203], a[48:51], a[0:3], v[200:203]
    v_add_u32 v46, v49, v46
    v_mfma_f32_16x16x32_bf16 v[204:207], a[48:51], a[4:7], v[204:207]
    v_add_u32 v47, v49, v47
    v_mfma_f32_16x16x32_bf16 v[208:211], a[48:51], a[8:11], v[208:211]
    v_mfma_f32_16x16x32_bf16 v[212:215], a[48:51], a[12:15], v[212:215]
    v_mfma_f32_16x16x32_bf16 v[216:219], a[48:51], a[32:35], v[216:219]
    s_waitcnt vmcnt(12) lgkmcnt(0)
    s_barrier
    s_cmp_eq_u32 s3, 1
    s_cbranch_scc0 .notw_11
    s_mul_i32 s76, s4, 294912
    v_mul_u32_u24 v254, 4608, v1
    v_add_u32 v254, s76, v254
    global_load_dword v255, v254, s[30:31]
.notw_11:
    s_mov_b64 exec, 1
    global_load_dword v252, v250, s[32:33] sc1
    s_mov_b64 exec, -1
    v_mfma_f32_16x16x32_bf16 v[96:99], a[88:91], a[52:55], v[96:99]
    ds_read_b64_tr_b16 a[36:37], v42 offset:0
    v_mfma_f32_16x16x32_bf16 v[100:103], a[88:91], a[56:59], v[100:103]
    ds_read_b64_tr_b16 a[38:39], v42 offset:432
    s_add_u32 m0, s67, 36864
    v_mfma_f32_16x16x32_bf16 v[104:107], a[88:91], a[60:63], v[104:107]
    buffer_load_dwordx4 v10, s[36:39], s64 offen lds
    ds_read_b128 a[0:3], v36 offset:0
    v_mfma_f32_16x16x32_bf16 v[108:111], a[88:91], a[64:67], v[108:111]
    v_mfma_f32_16x16x32_bf16 v[112:115], a[88:91], a[68:71], v[112:115]
    ds_read_b128 a[4:7], v36 offset:2048
    s_add_u32 m0, s67, 40960
    v_mfma_f32_16x16x32_bf16 v[116:119], a[88:91], a[72:75], v[116:119]
    buffer_load_dwordx4 v11, s[36:39], s64 offen lds
    ds_read_b128 a[8:11], v36 offset:4096
    v_mfma_f32_16x16x32_bf16 v[120:123], a[88:91], a[76:79], v[120:123]
    v_mfma_f32_16x16x32_bf16 v[124:127], a[88:91], a[80:83], v[124:127]
    ds_read_b128 a[12:15], v36 offset:6144
    v_mfma_f32_16x16x32_bf16 v[128:131], a[92:95], a[52:55], v[128:131]
    ds_read_b128 a[16:19], v38 offset:0
    s_add_u32 m0, s67, 45056
    v_mfma_f32_16x16x32_bf16 v[132:135], a[92:95], a[56:59], v[132:135]
    buffer_load_dwordx4 v12, s[36:39], s64 offen lds
    ds_read_b128 a[20:23], v38 offset:2048
    v_mfma_f32_16x16x32_bf16 v[136:139], a[92:95], a[60:63], v[136:139]
    v_mfma_f32_16x16x32_bf16 v[140:143], a[92:95], a[64:67], v[140:143]
    ds_read_b128 a[24:27], v38 offset:4096
    v_mfma_f32_16x16x32_bf16 v[144:147], a[92:95], a[68:71], v[144:147]
    ds_read_b128 a[28:31], v38 offset:6144
    s_add_u32 m0, s67, 49152
    v_mfma_f32_16x16x32_bf16 v[148:151], a[92:95], a[72:75], v[148:151]
    buffer_load_dwordx4 v13, s[36:39], s64 offen lds
    v_mfma_f32_16x16x32_bf16 v[152:155], a[92:95], a[76:79], v[152:155]
    ds_read_b64_tr_b16 a[40:41], v42 offset:144
    v_mfma_f32_16x16x32_bf16 v[156:159], a[92:95], a[80:83], v[156:159]
    ds_read_b64_tr_b16 a[42:43], v42 offset:576
    s_add_u32 m0, s67, 110592
    v_mfma_f32_16x16x32_bf16 v[192:195], a[92:95], a[84:87], v[192:195]
    buffer_load_dwordx4 v14, s[40:43], s65 offen lds
    ds_read_b128 a[32:35], v40 offset:0
    v_mfma_f32_16x16x32_bf16 v[160:163], a[52:55], a[96:99], v[160:163]
    v_mfma_f32_16x16x32_bf16 v[164:167], a[56:59], a[96:99], v[164:167]
    ds_read_b64_tr_b16 a[44:45], v42 offset:288
    v_mfma_f32_16x16x32_bf16 v[168:171], a[60:63], a[96:99], v[168:171]
    ds_read_b64_tr_b16 a[46:47], v42 offset:720
    s_add_u32 m0, s67, 114688
    v_mfma_f32_16x16x32_bf16 v[172:175], a[64:67], a[96:99], v[172:175]
    buffer_load_dwordx4 v15, s[40:43], s65 offen lds
    v_mfma_f32_16x16x32_bf16 v[176:179], a[68:71], a[96:99], v[176:179]
    ds_read_b64_tr_b16 a[48:49], v44 offset:0
    v_mfma_f32_16x16x32_bf16 v[180:183], a[72:75], a[96:99], v[180:183]
    ds_read_b64_tr_b16 a[50:51], v45 offset:0
    v_mfma_f32_16x16x32_bf16 v[184:187], a[76:79], a[96:99], v[184:187]
    s_add_u32 m0, s67, 118784
    v_mfma_f32_16x16x32_bf16 v[188:191], a[80:83], a[96:99], v[188:191]
    buffer_load_dwordx4 v16, s[40:43], s65 offen lds
    v_mfma_f32_16x16x32_bf16 v[196:199], a[84:87], a[96:99], v[196:199]
    v_mfma_f32_16x16x32_bf16 v[200:203], a[100:103], a[52:55], v[200:203]
    s_add_u32 m0, s67, 122880
    v_mfma_f32_16x16x32_bf16 v[204:207], a[100:103], a[56:59], v[204:207]
    buffer_load_dwordx4 v17, s[40:43], s65 offen lds
    v_mfma_f32_16x16x32_bf16 v[208:211], a[100:103], a[60:63], v[208:211]
    v_mfma_f32_16x16x32_bf16 v[212:215], a[100:103], a[64:67], v[212:215]
    v_mfma_f32_16x16x32_bf16 v[216:219], a[100:103], a[84:87], v[216:219]
    s_waitcnt lgkmcnt(0)
    s_add_u32 m0, s67, 126976
    v_mfma_f32_16x16x32_bf16 v[96:99], a[36:39], a[0:3], v[96:99]
    buffer_load_dwordx4 v18, s[40:43], s65 offen lds
    ds_read_b64_tr_b16 a[88:89], v42 offset:13824
    v_mfma_f32_16x16x32_bf16 v[100:103], a[36:39], a[4:7], v[100:103]
    ds_read_b64_tr_b16 a[90:91], v42 offset:14256
    v_mfma_f32_16x16x32_bf16 v[104:107], a[36:39], a[8:11], v[104:107]
    ds_read_b128 a[52:55], v37 offset:0
    v_mfma_f32_16x16x32_bf16 v[108:111], a[36:39], a[12:15], v[108:111]
    s_add_u32 m0, s67, 131072
    v_mfma_f32_16x16x32_bf16 v[112:115], a[36:39], a[16:19], v[112:115]
    buffer_load_dwordx4 v19, s[40:43], s65 offen lds
    ds_read_b128 a[56:59], v37 offset:2048
    v_mfma_f32_16x16x32_bf16 v[116:119], a[36:39], a[20:23], v[116:119]
    ds_read_b128 a[60:63], v37 offset:4096
    v_mfma_f32_16x16x32_bf16 v[120:123], a[36:39], a[24:27], v[120:123]
    s_mov_b32 m0, s70
    v_mfma_f32_16x16x32_bf16 v[124:127], a[36:39], a[28:31], v[124:127]
    buffer_load_dwordx4 v20, s[44:47], s66 offen lds
    ds_read_b128 a[64:67], v37 offset:6144
    v_mfma_f32_16x16x32_bf16 v[128:131], a[40:43], a[0:3], v[128:131]
    ds_read_b128 a[68:71], v39 offset:0
    v_mfma_f32_16x16x32_bf16 v[132:135], a[40:43], a[4:7], v[132:135]
    ds_read_b128 a[72:75], v39 offset:2048
    v_mfma_f32_16x16x32_bf16 v[136:139], a[40:43], a[8:11], v[136:139]
    s_add_u32 m0, s71, 137216
    v_mfma_f32_16x16x32_bf16 v[140:143], a[40:43], a[12:15], v[140:143]
    buffer_load_dword v21, s[40:43], s65 offen lds
    ds_read_b128 a[76:79], v39 offset:4096
    v_mfma_f32_16x16x32_bf16 v[144:147], a[40:43], a[16:19], v[144:147]
    ds_read_b128 a[80:83], v39 offset:6144
    v_mfma_f32_16x16x32_bf16 v[148:151], a[40:43], a[20:23], v[148:151]
    v_mfma_f32_16x16x32_bf16 v[152:155], a[40:43], a[24:27], v[152:155]
    ds_read_b64_tr_b16 a[92:93], v42 offset:13968
    v_mfma_f32_16x16x32_bf16 v[156:159], a[40:43], a[28:31], v[156:159]
    ds_read_b64_tr_b16 a[94:95], v42 offset:14400
    v_mfma_f32_16x16x32_bf16 v[192:195], a[40:43], a[32:35], v[192:195]
    ds_read_b128 a[84:87], v41 offset:0
    v_mfma_f32_16x16x32_bf16 v[160:163], a[0:3], a[44:47], v[160:163]
    v_mfma_f32_16x16x32_bf16 v[164:167], a[4:7], a[44:47], v[164:167]
    ds_read_b64_tr_b16 a[96:97], v42 offset:14112
    v_mfma_f32_16x16x32_bf16 v[168:171], a[8:11], a[44:47], v[168:171]
    ds_read_b64_tr_b16 a[98:99], v42 offset:14544
    v_mfma_f32_16x16x32_bf16 v[172:175], a[12:15], a[44:47], v[172:175]
    v_mfma_f32_16x16x32_bf16 v[176:179], a[16:19], a[44:47], v[176:179]
    ds_read_b64_tr_b16 a[100:101], v46 offset:0
    v_mfma_f32_16x16x32_bf16 v[180:183], a[20:23], a[44:47], v[180:183]
    ds_read_b64_tr_b16 a[102:103], v47 offset:0
    v_mfma_f32_16x16x32_bf16 v[184:187], a[24:27], a[44:47], v[184:187]
    v_mfma_f32_16x16x32_bf16 v[188:191], a[28:31], a[44:47], v[188:191]
    v_add_u32 v44, v48, v44
    v_mfma_f32_16x16x32_bf16 v[196:199], a[32:35], a[44:47], v[196:199]
    v_add_u32 v45, v48, v45
    v_mfma_f32_16x16x32_bf16 v[200:203], a[48:51], a[0:3], v[200:203]
    v_add_u32 v46, v48, v46
    v_mfma_f32_16x16x32_bf16 v[204:207], a[48:51], a[4:7], v[204:207]
    v_add_u32 v47, v48, v47
    v_mfma_f32_16x16x32_bf16 v[208:211], a[48:51], a[8:11], v[208:211]
    v_mfma_f32_16x16x32_bf16 v[212:215], a[48:51], a[12:15], v[212:215]
    v_mfma_f32_16x16x32_bf16 v[216:219], a[48:51], a[32:35], v[216:219]
    s_waitcnt vmcnt(12) lgkmcnt(0)
    s_barrier
    s_cmp_eq_u32 s3, 0
    s_cbranch_scc0 .w0_12
    s_mov_b64 exec, 1
    v_mov_b32 v8, 0
    global_load_dword v88, v89, s[34:35] sc1
    s_mov_b64 exec, -1
.w0_12:
    v_mfma_f32_16x16x32_bf16 v[96:99], a[88:91], a[52:55], v[96:99]
    s_movk_i32 s36, 18432
    s_movk_i32 s37, 27648
    ds_read_b64_tr_b16 a[36:37], v42 offset:27648
    v_mfma_f32_16x16x32_bf16 v[100:103], a[88:91], a[56:59], v[100:103]
    s_mov_b32 s39, 36864
    s_mov_b32 s40, 55296
    ds_read_b64_tr_b16 a[38:39], v42 offset:28080
    v_readfirstlane_b32 s76, v252
    s_nop 0
    s_cmp_eq_u32 s76, 8
    s_cbranch_scc0 .Lfb
.Lfbret:
    s_cmp_lt_u32 s3, 2
    s_cselect_b32 s44, s52, s56
    s_cselect_b32 s45, s53, s57
    s_mov_b32 s46, s54
    s_cselect_b32 s38, s36, s37
    s_cselect_b32 s41, s39, 0
    v_mfma_f32_16x16x32_bf16 v[104:107], a[88:91], a[60:63], v[104:107]
    ds_read_b128 a[0:3], v36 offset:18432
    v_mfma_f32_16x16x32_bf16 v[108:111], a[88:91], a[64:67], v[108:111]
    v_mfma_f32_16x16x32_bf16 v[112:115], a[88:91], a[68:71], v[112:115]
    ds_read_b128 a[4:7], v36 offset:20480
    v_mfma_f32_16x16x32_bf16 v[116:119], a[88:91], a[72:75], v[116:119]
    ds_read_b128 a[8:11], v36 offset:22528
    v_mfma_f32_16x16x32_bf16 v[120:123], a[88:91], a[76:79], v[120:123]
    v_mfma_f32_16x16x32_bf16 v[124:127], a[88:91], a[80:83], v[124:127]
    ds_read_b128 a[12:15], v36 offset:24576
    v_mfma_f32_16x16x32_bf16 v[128:131], a[92:95], a[52:55], v[128:131]
    ds_read_b128 a[16:19], v38 offset:18432
    s_add_u32 m0, s67, 55296
    v_mfma_f32_16x16x32_bf16 v[132:135], a[92:95], a[56:59], v[132:135]
    buffer_load_dwordx4 v22, s[56:59], 0 offen lds
    ds_read_b128 a[20:23], v38 offset:20480
    v_mfma_f32_16x16x32_bf16 v[136:139], a[92:95], a[60:63], v[136:139]
    v_mfma_f32_16x16x32_bf16 v[140:143], a[92:95], a[64:67], v[140:143]
    ds_read_b128 a[24:27], v38 offset:22528
    v_mfma_f32_16x16x32_bf16 v[144:147], a[92:95], a[68:71], v[144:147]
    ds_read_b128 a[28:31], v38 offset:24576
    v_mfma_f32_16x16x32_bf16 v[148:151], a[92:95], a[72:75], v[148:151]
    v_mfma_f32_16x16x32_bf16 v[152:155], a[92:95], a[76:79], v[152:155]
    ds_read_b64_tr_b16 a[40:41], v42 offset:27792
    v_mfma_f32_16x16x32_bf16 v[156:159], a[92:95], a[80:83], v[156:159]
    ds_read_b64_tr_b16 a[42:43], v42 offset:28224
    v_mfma_f32_16x16x32_bf16 v[192:195], a[92:95], a[84:87], v[192:195]
    ds_read_b128 a[32:35], v40 offset:18432
    v_mfma_f32_16x16x32_bf16 v[160:163], a[52:55], a[96:99], v[160:163]
    s_add_u32 m0, s67, 59392
    v_mfma_f32_16x16x32_bf16 v[164:167], a[56:59], a[96:99], v[164:167]
    buffer_load_dwordx4 v23, s[56:59], 0 offen lds
    ds_read_b64_tr_b16 a[44:45], v42 offset:27936
    v_mfma_f32_16x16x32_bf16 v[168:171], a[60:63], a[96:99], v[168:171]
    ds_read_b64_tr_b16 a[46:47], v42 offset:28368
    v_mfma_f32_16x16x32_bf16 v[172:175], a[64:67], a[96:99], v[172:175]
    v_mfma_f32_16x16x32_bf16 v[176:179], a[68:71], a[96:99], v[176:179]
    ds_read_b64_tr_b16 a[48:49], v44 offset:0
    v_mfma_f32_16x16x32_bf16 v[180:183], a[72:75], a[96:99], v[180:183]
    ds_read_b64_tr_b16 a[50:51], v45 offset:0
    v_mfma_f32_16x16x32_bf16 v[184:187], a[76:79], a[96:99], v[184:187]
    v_mfma_f32_16x16x32_bf16 v[188:191], a[80:83], a[96:99], v[188:191]
    v_mfma_f32_16x16x32_bf16 v[196:199], a[84:87], a[96:99], v[196:199]
    v_mfma_f32_16x16x32_bf16 v[200:203], a[100:103], a[52:55], v[200:203]
    s_add_u32 m0, s67, 63488
    v_mfma_f32_16x16x32_bf16 v[204:207], a[100:103], a[56:59], v[204:207]
    buffer_load_dwordx4 v24, s[56:59], 0 offen lds
    v_mfma_f32_16x16x32_bf16 v[208:211], a[100:103], a[60:63], v[208:211]
    v_mfma_f32_16x16x32_bf16 v[212:215], a[100:103], a[64:67], v[212:215]
    v_mfma_f32_16x16x32_bf16 v[216:219], a[100:103], a[84:87], v[216:219]
    s_waitcnt lgkmcnt(0)
    v_mfma_f32_16x16x32_bf16 v[96:99], a[36:39], a[0:3], v[96:99]
    ds_read_b64_tr_b16 a[88:89], v42 offset:41472
    v_mfma_f32_16x16x32_bf16 v[100:103], a[36:39], a[4:7], v[100:103]
    ds_read_b64_tr_b16 a[90:91], v42 offset:41904
    v_mfma_f32_16x16x32_bf16 v[104:107], a[36:39], a[8:11], v[104:107]
    ds_read_b128 a[52:55], v37 offset:18432
    v_mfma_f32_16x16x32_bf16 v[108:111], a[36:39], a[12:15], v[108:111]
    v_mfma_f32_16x16x32_bf16 v[112:115], a[36:39], a[16:19], v[112:115]
    ds_read_b128 a[56:59], v37 offset:20480
    s_add_u32 m0, s67, 67584
    v_mfma_f32_16x16x32_bf16 v[116:119], a[36:39], a[20:23], v[116:119]
    buffer_load_dwordx4 v25, s[56:59], 0 offen lds
    ds_read_b128 a[60:63], v37 offset:22528
    v_mfma_f32_16x16x32_bf16 v[120:123], a[36:39], a[24:27], v[120:123]
    v_mfma_f32_16x16x32_bf16 v[124:127], a[36:39], a[28:31], v[124:127]
    ds_read_b128 a[64:67], v37 offset:24576
    v_mfma_f32_16x16x32_bf16 v[128:131], a[40:43], a[0:3], v[128:131]
    ds_read_b128 a[68:71], v39 offset:18432
    v_mfma_f32_16x16x32_bf16 v[132:135], a[40:43], a[4:7], v[132:135]
    ds_read_b128 a[72:75], v39 offset:20480
    v_mfma_f32_16x16x32_bf16 v[136:139], a[40:43], a[8:11], v[136:139]
    v_mfma_f32_16x16x32_bf16 v[140:143], a[40:43], a[12:15], v[140:143]
    ds_read_b128 a[76:79], v39 offset:22528
    v_mfma_f32_16x16x32_bf16 v[144:147], a[40:43], a[16:19], v[144:147]
    ds_read_b128 a[80:83], v39 offset:24576
    v_mfma_f32_16x16x32_bf16 v[148:151], a[40:43], a[20:23], v[148:151]
    s_add_u32 m0, s67, 71680
    v_mfma_f32_16x16x32_bf16 v[152:155], a[40:43], a[24:27], v[152:155]
    buffer_load_dwordx4 v26, s[56:59], 0 offen lds
    ds_read_b64_tr_b16 a[92:93], v42 offset:41616
    v_mfma_f32_16x16x32_bf16 v[156:159], a[40:43], a[28:31], v[156:159]
    ds_read_b64_tr_b16 a[94:95], v42 offset:42048
    v_mfma_f32_16x16x32_bf16 v[192:195], a[40:43], a[32:35], v[192:195]
    ds_read_b128 a[84:87], v41 offset:18432
    v_mfma_f32_16x16x32_bf16 v[160:163], a[0:3], a[44:47], v[160:163]
    v_mfma_f32_16x16x32_bf16 v[164:167], a[4:7], a[44:47], v[164:167]
    ds_read_b64_tr_b16 a[96:97], v42 offset:41760
    v_mfma_f32_16x16x32_bf16 v[168:171], a[8:11], a[44:47], v[168:171]
    ds_read_b64_tr_b16 a[98:99], v42 offset:42192
    v_mfma_f32_16x16x32_bf16 v[172:175], a[12:15], a[44:47], v[172:175]
    v_mfma_f32_16x16x32_bf16 v[176:179], a[16:19], a[44:47], v[176:179]
    ds_read_b64_tr_b16 a[100:101], v46 offset:0
    v_mfma_f32_16x16x32_bf16 v[180:183], a[20:23], a[44:47], v[180:183]
    ds_read_b64_tr_b16 a[102:103], v47 offset:0
    s_add_u32 m0, s67, 75776
    v_mfma_f32_16x16x32_bf16 v[184:187], a[24:27], a[44:47], v[184:187]
    buffer_load_dwordx4 v27, s[56:59], 0 offen lds
    v_mfma_f32_16x16x32_bf16 v[188:191], a[28:31], a[44:47], v[188:191]
    v_add_u32 v44, v48, v44
    v_mfma_f32_16x16x32_bf16 v[196:199], a[32:35], a[44:47], v[196:199]
    v_add_u32 v45, v48, v45
    v_mfma_f32_16x16x32_bf16 v[200:203], a[48:51], a[0:3], v[200:203]
    v_add_u32 v46, v48, v46
    v_mfma_f32_16x16x32_bf16 v[204:207], a[48:51], a[4:7], v[204:207]
    v_add_u32 v47, v48, v47
    v_mfma_f32_16x16x32_bf16 v[208:211], a[48:51], a[8:11], v[208:211]
    v_mfma_f32_16x16x32_bf16 v[212:215], a[48:51], a[12:15], v[212:215]
    v_mfma_f32_16x16x32_bf16 v[216:219], a[48:51], a[32:35], v[216:219]
    s_waitcnt vmcnt(6) lgkmcnt(0)
    s_barrier
    s_cmp_eq_u32 s3, 0
    s_cbranch_scc0 .w0_13
    v_readfirstlane_b32 s76, v88
    s_nop 0
    s_cmp_eq_u32 s76, 32
    s_cselect_b32 s76, 3, 1
    s_mul_i32 s76, s76, s12
    v_mov_b32 v8, s76
    v_mov_b32 v9, 157760
    ds_write_b32 v9, v8
.w0_13:
    v_mfma_f32_16x16x32_bf16 v[96:99], a[88:91], a[52:55], v[96:99]
    ds_read_b64_tr_b16 a[36:37], v43 offset:0
    s_mov_b32 m0, s68
    v_mfma_f32_16x16x32_bf16 v[100:103], a[88:91], a[56:59], v[100:103]
    buffer_load_dwordx4 v28, s[44:47], 0 offen lds
    ds_read_b64_tr_b16 a[38:39], v43 offset:432
    v_mfma_f32_16x16x32_bf16 v[104:107], a[88:91], a[60:63], v[104:107]
    ds_read_b128 a[0:3], v36 offset:36864
    v_mfma_f32_16x16x32_bf16 v[108:111], a[88:91], a[64:67], v[108:111]
    v_mfma_f32_16x16x32_bf16 v[112:115], a[88:91], a[68:71], v[112:115]
    ds_read_b128 a[4:7], v36 offset:38912
    v_mfma_f32_16x16x32_bf16 v[116:119], a[88:91], a[72:75], v[116:119]
    s_branch .Lsk3
.Lpad3:
    s_branch .Lpret
.Lsk3:
    ds_read_b128 a[8:11], v36 offset:40960
    v_mfma_f32_16x16x32_bf16 v[120:123], a[88:91], a[76:79], v[120:123]
    v_mfma_f32_16x16x32_bf16 v[124:127], a[88:91], a[80:83], v[124:127]
    ds_read_b128 a[12:15], v36 offset:43008
    v_mfma_f32_16x16x32_bf16 v[128:131], a[92:95], a[52:55], v[128:131]
    ds_read_b128 a[16:19], v38 offset:36864
    v_mfma_f32_16x16x32_bf16 v[132:135], a[92:95], a[56:59], v[132:135]
    ds_read_b128 a[20:23], v38 offset:38912
    s_add_u32 m0, s71, 81920
    v_mfma_f32_16x16x32_bf16 v[136:139], a[92:95], a[60:63], v[136:139]
    buffer_load_dword v29, s[56:59], 0 offen lds
    v_mfma_f32_16x16x32_bf16 v[140:143], a[92:95], a[64:67], v[140:143]
    ds_read_b128 a[24:27], v38 offset:40960
    v_mfma_f32_16x16x32_bf16 v[144:147], a[92:95], a[68:71], v[144:147]
    ds_read_b128 a[28:31], v38 offset:43008
    v_mfma_f32_16x16x32_bf16 v[148:151], a[92:95], a[72:75], v[148:151]
    v_mfma_f32_16x16x32_bf16 v[152:155], a[92:95], a[76:79], v[152:155]
    ds_read_b64_tr_b16 a[40:41], v43 offset:144
    v_mfma_f32_16x16x32_bf16 v[156:159], a[92:95], a[80:83], v[156:159]
    ds_read_b64_tr_b16 a[42:43], v43 offset:576
    v_mfma_f32_16x16x32_bf16 v[192:195], a[92:95], a[84:87], v[192:195]
    ds_read_b128 a[32:35], v40 offset:36864
    v_mfma_f32_16x16x32_bf16 v[160:163], a[52:55], a[96:99], v[160:163]
    v_mfma_f32_16x16x32_bf16 v[164:167], a[56:59], a[96:99], v[164:167]
    ds_read_b64_tr_b16 a[44:45], v43 offset:288
    s_add_u32 m0, s67, 0
    v_mfma_f32_16x16x32_bf16 v[168:171], a[60:63], a[96:99], v[168:171]
    buffer_load_dwordx4 v22, s[52:55], 0 offen lds
    ds_read_b64_tr_b16 a[46:47], v43 offset:720
    v_mfma_f32_16x16x32_bf16 v[172:175], a[64:67], a[96:99], v[172:175]
    v_mfma_f32_16x16x32_bf16 v[176:179], a[68:71], a[96:99], v[176:179]
    ds_read_b64_tr_b16 a[48:49], v44 offset:0
    v_mfma_f32_16x16x32_bf16 v[180:183], a[72:75], a[96:99], v[180:183]
    ds_read_b64_tr_b16 a[50:51], v45 offset:0
    v_mfma_f32_16x16x32_bf16 v[184:187], a[76:79], a[96:99], v[184:187]
    v_mfma_f32_16x16x32_bf16 v[188:191], a[80:83], a[96:99], v[188:191]
    v_mfma_f32_16x16x32_bf16 v[196:199], a[84:87], a[96:99], v[196:199]
    v_mfma_f32_16x16x32_bf16 v[200:203], a[100:103], a[52:55], v[200:203]
    v_mfma_f32_16x16x32_bf16 v[204:207], a[100:103], a[56:59], v[204:207]
    s_add_u32 m0, s67, 4096
    v_mfma_f32_16x16x32_bf16 v[208:211], a[100:103], a[60:63], v[208:211]
    buffer_load_dwordx4 v23, s[52:55], 0 offen lds
    v_mfma_f32_16x16x32_bf16 v[212:215], a[100:103], a[64:67], v[212:215]
    v_mfma_f32_16x16x32_bf16 v[216:219], a[100:103], a[84:87], v[216:219]
    s_waitcnt lgkmcnt(0)
    v_mfma_f32_16x16x32_bf16 v[96:99], a[36:39], a[0:3], v[96:99]
    ds_read_b64_tr_b16 a[88:89], v43 offset:13824
    v_mfma_f32_16x16x32_bf16 v[100:103], a[36:39], a[4:7], v[100:103]
    ds_read_b64_tr_b16 a[90:91], v43 offset:14256
    v_mfma_f32_16x16x32_bf16 v[104:107], a[36:39], a[8:11], v[104:107]
    ds_read_b128 a[52:55], v37 offset:36864
    v_mfma_f32_16x16x32_bf16 v[108:111], a[36:39], a[12:15], v[108:111]
    v_mfma_f32_16x16x32_bf16 v[112:115], a[36:39], a[16:19], v[112:115]
    ds_read_b128 a[56:59], v37 offset:38912
    v_mfma_f32_16x16x32_bf16 v[116:119], a[36:39], a[20:23], v[116:119]
    ds_read_b128 a[60:63], v37 offset:40960
    s_add_u32 m0, s67, 8192
    v_mfma_f32_16x16x32_bf16 v[120:123], a[36:39], a[24:27], v[120:123]
    buffer_load_dwordx4 v24, s[52:55], 0 offen lds
    v_mfma_f32_16x16x32_bf16 v[124:127], a[36:39], a[28:31], v[124:127]
    ds_read_b128 a[64:67], v37 offset:43008
    v_mfma_f32_16x16x32_bf16 v[128:131], a[40:43], a[0:3], v[128:131]
    ds_read_b128 a[68:71], v39 offset:36864
    v_mfma_f32_16x16x32_bf16 v[132:135], a[40:43], a[4:7], v[132:135]
    ds_read_b128 a[72:75], v39 offset:38912
    v_mfma_f32_16x16x32_bf16 v[136:139], a[40:43], a[8:11], v[136:139]
    v_mfma_f32_16x16x32_bf16 v[140:143], a[40:43], a[12:15], v[140:143]
    ds_read_b128 a[76:79], v39 offset:40960
    v_mfma_f32_16x16x32_bf16 v[144:147], a[40:43], a[16:19], v[144:147]
    ds_read_b128 a[80:83], v39 offset:43008
    v_mfma_f32_16x16x32_bf16 v[148:151], a[40:43], a[20:23], v[148:151]
    v_mfma_f32_16x16x32_bf16 v[152:155], a[40:43], a[24:27], v[152:155]
    ds_read_b64_tr_b16 a[92:93], v43 offset:13968
    s_add_u32 m0, s67, 12288
    v_mfma_f32_16x16x32_bf16 v[156:159], a[40:43], a[28:31], v[156:159]
    buffer_load_dwordx4 v25, s[52:55], 0 offen lds
    ds_read_b64_tr_b16 a[94:95], v43 offset:14400
    v_mfma_f32_16x16x32_bf16 v[192:195], a[40:43], a[32:35], v[192:195]
    ds_read_b128 a[84:87], v41 offset:36864
    v_mfma_f32_16x16x32_bf16 v[160:163], a[0:3], a[44:47], v[160:163]
    v_mfma_f32_16x16x32_bf16 v[164:167], a[4:7], a[44:47], v[164:167]
    ds_read_b64_tr_b16 a[96:97], v43 offset:14112
    v_mfma_f32_16x16x32_bf16 v[168:171], a[8:11], a[44:47], v[168:171]
    ds_read_b64_tr_b16 a[98:99], v43 offset:14544
    v_mfma_f32_16x16x32_bf16 v[172:175], a[12:15], a[44:47], v[172:175]
    v_mfma_f32_16x16x32_bf16 v[176:179], a[16:19], a[44:47], v[176:179]
    ds_read_b64_tr_b16 a[100:101], v46 offset:0
    v_mfma_f32_16x16x32_bf16 v[180:183], a[20:23], a[44:47], v[180:183]
    ds_read_b64_tr_b16 a[102:103], v47 offset:0
    v_mfma_f32_16x16x32_bf16 v[184:187], a[24:27], a[44:47], v[184:187]
    s_add_u32 m0, s67, 82944
    v_mfma_f32_16x16x32_bf16 v[188:191], a[28:31], a[44:47], v[188:191]
    buffer_load_dwordx4 v22, s[56:59], s37 offen lds
    v_mfma_f32_16x16x32_bf16 v[196:199], a[32:35], a[44:47], v[196:199]
    v_mfma_f32_16x16x32_bf16 v[200:203], a[48:51], a[0:3], v[200:203]
    v_mfma_f32_16x16x32_bf16 v[204:207], a[48:51], a[4:7], v[204:207]
    v_mfma_f32_16x16x32_bf16 v[208:211], a[48:51], a[8:11], v[208:211]
    v_mfma_f32_16x16x32_bf16 v[212:215], a[48:51], a[12:15], v[212:215]
    v_mfma_f32_16x16x32_bf16 v[216:219], a[48:51], a[32:35], v[216:219]
    s_waitcnt lgkmcnt(0)
    v_mfma_f32_16x16x32_bf16 v[200:203], a[100:103], a[52:55], v[200:203]
    v_mfma_f32_16x16x32_bf16 v[204:207], a[100:103], a[56:59], v[204:207]
    v_mfma_f32_16x16x32_bf16 v[208:211], a[100:103], a[60:63], v[208:211]
    v_mfma_f32_16x16x32_bf16 v[212:215], a[100:103], a[64:67], v[212:215]
    v_mfma_f32_16x16x32_bf16 v[216:219], a[100:103], a[84:87], v[216:219]
    v_mfma_f32_16x16x32_bf16 v[96:99], a[88:91], a[52:55], v[96:99]
    v_mfma_f32_16x16x32_bf16 v[100:103], a[88:91], a[56:59], v[100:103]
    v_mfma_f32_16x16x32_bf16 v[104:107], a[88:91], a[60:63], v[104:107]
    v_mfma_f32_16x16x32_bf16 v[108:111], a[88:91], a[64:67], v[108:111]
    v_cvt_pk_bf16_f32 v220, v200, v201
    v_cvt_pk_bf16_f32 v221, v202, v203
    v_mfma_f32_16x16x32_bf16 v[112:115], a[88:91], a[68:71], v[112:115]
    v_cvt_pk_bf16_f32 v222, v204, v205
    v_cvt_pk_bf16_f32 v223, v206, v207
    s_add_u32 m0, s67, 87040
    v_mfma_f32_16x16x32_bf16 v[116:119], a[88:91], a[72:75], v[116:119]
    buffer_load_dwordx4 v23, s[56:59], s37 offen lds
    v_cvt_pk_bf16_f32 v224, v208, v209
    v_cvt_pk_bf16_f32 v225, v210, v211
    v_mfma_f32_16x16x32_bf16 v[120:123], a[88:91], a[76:79], v[120:123]
    v_cvt_pk_bf16_f32 v226, v212, v213
    v_cvt_pk_bf16_f32 v227, v214, v215
    v_mfma_f32_16x16x32_bf16 v[124:127], a[88:91], a[80:83], v[124:127]
    v_cvt_pk_bf16_f32 v228, v216, v217
    v_cvt_pk_bf16_f32 v229, v218, v219
    v_mfma_f32_16x16x32_bf16 v[128:131], a[92:95], a[52:55], v[128:131]
    ds_write_b64 v70, v[220:221] offset:512
    v_mfma_f32_16x16x32_bf16 v[132:135], a[92:95], a[56:59], v[132:135]
    ds_write_b64 v70, v[222:223] offset:1024
    v_mfma_f32_16x16x32_bf16 v[136:139], a[92:95], a[60:63], v[136:139]
    ds_write_b64 v70, v[224:225] offset:1536
    v_mfma_f32_16x16x32_bf16 v[140:143], a[92:95], a[64:67], v[140:143]
    ds_write_b64 v70, v[226:227] offset:2048
    v_mfma_f32_16x16x32_bf16 v[144:147], a[92:95], a[68:71], v[144:147]
    ds_write_b64 v70, v[228:229] offset:0
    s_lshl_b32 s72, s7, 2
    s_xor_b32 s73, s3, 2
    s_add_u32 s72, s72, s73
    s_cmp_lt_u32 s72, 2
    s_cbranch_scc0 .nogate3_14
    s_mov_b32 s78, 0
    s_mov_b32 s79, 0xffff
    s_mov_b64 exec, s[78:79]
    buffer_store_dword v200, v87, s[48:51], 0 offen offset:0 sc1
    buffer_store_dword v204, v87, s[48:51], 0 offen offset:64 sc1
    buffer_store_dword v208, v87, s[48:51], 0 offen offset:128 sc1
    buffer_store_dword v212, v87, s[48:51], 0 offen offset:192 sc1
    s_mov_b64 exec, -1
.nogate3_14:
    v_mfma_f32_16x16x32_bf16 v[148:151], a[92:95], a[72:75], v[148:151]
    v_cvt_pk_bf16_f32 v96, v96, v97
    v_cvt_pk_bf16_f32 v97, v98, v99
    v_mov_b32 v99, 0
    v_mfma_f32_16x16x32_bf16 v[152:155], a[92:95], a[76:79], v[152:155]
    v_cvt_pk_bf16_f32 v100, v100, v101
    v_cvt_pk_bf16_f32 v101, v102, v103
    v_mov_b32 v103, 0
    s_add_u32 m0, s67, 91136
    v_mfma_f32_16x16x32_bf16 v[156:159], a[92:95], a[80:83], v[156:159]
    buffer_load_dwordx4 v24, s[56:59], s37 offen lds
    v_cvt_pk_bf16_f32 v104, v104, v105
    v_cvt_pk_bf16_f32 v105, v106, v107
    v_mov_b32 v107, 0
    v_mfma_f32_16x16x32_bf16 v[192:195], a[92:95], a[84:87], v[192:195]
    v_cvt_pk_bf16_f32 v108, v108, v109
    v_cvt_pk_bf16_f32 v109, v110, v111
    v_mov_b32 v111, 0
    v_mfma_f32_16x16x32_bf16 v[160:163], a[52:55], a[96:99], v[160:163]
    v_cvt_pk_bf16_f32 v112, v112, v113
    v_cvt_pk_bf16_f32 v113, v114, v115
    v_mov_b32 v115, 0
    v_mfma_f32_16x16x32_bf16 v[164:167], a[56:59], a[96:99], v[164:167]
    v_cvt_pk_bf16_f32 v116, v116, v117
    v_cvt_pk_bf16_f32 v117, v118, v119
    v_mov_b32 v119, 0
    v_mfma_f32_16x16x32_bf16 v[168:171], a[60:63], a[96:99], v[168:171]
    v_cvt_pk_bf16_f32 v120, v120, v121
    v_cvt_pk_bf16_f32 v121, v122, v123
    v_mov_b32 v123, 0
    v_mfma_f32_16x16x32_bf16 v[172:175], a[64:67], a[96:99], v[172:175]
    v_cvt_pk_bf16_f32 v124, v124, v125
    v_cvt_pk_bf16_f32 v125, v126, v127
    v_mov_b32 v127, 0
    v_mfma_f32_16x16x32_bf16 v[176:179], a[68:71], a[96:99], v[176:179]
    v_cvt_pk_bf16_f32 v128, v128, v129
    v_cvt_pk_bf16_f32 v129, v130, v131
    v_mov_b32 v131, 0
    v_mfma_f32_16x16x32_bf16 v[180:183], a[72:75], a[96:99], v[180:183]
    v_cvt_pk_bf16_f32 v132, v132, v133
    v_cvt_pk_bf16_f32 v133, v134, v135
    v_mov_b32 v135, 0
    v_mfma_f32_16x16x32_bf16 v[184:187], a[76:79], a[96:99], v[184:187]
    v_cvt_pk_bf16_f32 v136, v136, v137
    v_cvt_pk_bf16_f32 v137, v138, v139
    v_mov_b32 v139, 0
    v_mfma_f32_16x16x32_bf16 v[188:191], a[80:83], a[96:99], v[188:191]
    v_cvt_pk_bf16_f32 v140, v140, v141
    v_cvt_pk_bf16_f32 v141, v142, v143
    v_mov_b32 v143, 0
    s_add_u32 m0, s67, 95232
    v_mfma_f32_16x16x32_bf16 v[196:199], a[84:87], a[96:99], v[196:199]
    buffer_load_dwordx4 v25, s[56:59], s37 offen lds
    v_cvt_pk_bf16_f32 v144, v144, v145
    v_cvt_pk_bf16_f32 v145, v146, v147
    v_mov_b32 v147, 0
    s_waitcnt lgkmcnt(0)
    s_barrier
    ds_read_b32 v98, v71 offset:512
    ds_read_b32 v102, v71 offset:1024
    ds_read_b32 v106, v71 offset:1536
    ds_read_b32 v110, v71 offset:2048
    ds_read_b32 v114, v72 offset:512
    ds_read_b32 v118, v72 offset:1024
    ds_read_b32 v122, v72 offset:1536
    ds_read_b32 v126, v72 offset:2048
    v_cvt_pk_bf16_f32 v148, v148, v149
    v_cvt_pk_bf16_f32 v149, v150, v151
    v_mov_b32 v151, 0
    v_cvt_pk_bf16_f32 v152, v152, v153
    v_cvt_pk_bf16_f32 v153, v154, v155
    v_mov_b32 v155, 0
    v_cvt_pk_bf16_f32 v156, v156, v157
    v_cvt_pk_bf16_f32 v157, v158, v159
    v_mov_b32 v159, 0
    v_cvt_pk_bf16_f32 v192, v192, v193
    v_cvt_pk_bf16_f32 v193, v194, v195
    v_mov_b32 v195, 0
    ds_read_b32 v194, v73
    ds_read_b32 v130, v73 offset:512
    ds_read_b32 v134, v73 offset:1024
    ds_read_b32 v138, v73 offset:1536
    ds_read_b32 v142, v73 offset:2048
    ds_read_b32 v146, v74 offset:512
    ds_read_b32 v150, v74 offset:1024
    ds_read_b32 v154, v74 offset:1536
    ds_read_b32 v158, v74 offset:2048
    v_mov_b32 v9, 157760
    ds_read_b32 v88, v9
    v_cvt_pk_bf16_f32 v226, v160, v161
    v_cvt_pk_bf16_f32 v227, v162, v163
    v_cvt_pk_bf16_f32 v224, v164, v165
    v_cvt_pk_bf16_f32 v225, v166, v167
    v_cvt_pk_bf16_f32 v222, v168, v169
    v_cvt_pk_bf16_f32 v223, v170, v171
    s_add_u32 m0, s67, 99328
    v_cvt_pk_bf16_f32 v220, v172, v173
    buffer_load_dwordx4 v26, s[56:59], s37 offen lds
    v_cvt_pk_bf16_f32 v221, v174, v175
    v_cvt_pk_bf16_f32 v236, v176, v177
    v_cvt_pk_bf16_f32 v237, v178, v179
    v_cvt_pk_bf16_f32 v234, v180, v181
    v_cvt_pk_bf16_f32 v235, v182, v183
    v_cvt_pk_bf16_f32 v232, v184, v185
    v_cvt_pk_bf16_f32 v233, v186, v187
    v_cvt_pk_bf16_f32 v230, v188, v189
    v_cvt_pk_bf16_f32 v231, v190, v191
    v_cvt_pk_bf16_f32 v228, v196, v197
    v_cvt_pk_bf16_f32 v229, v198, v199
    v_cvt_pk_bf16_f32 v238, v196, v197
    v_cvt_pk_bf16_f32 v239, v198, v199
    s_waitcnt lgkmcnt(0)
    v_mfma_f32_16x16x32_bf16 v[160:163], v[128:131], v[96:99], v[50:53]
    ds_read_b64_tr_b16 a[208:209], v75 offset:512
    v_mfma_f32_16x16x32_bf16 v[200:203], v[192:195], v[96:99], v[58:61]
    ds_read_b64_tr_b16 a[210:211], v75 offset:0
    v_mfma_f32_16x16x32_bf16 v[164:167], v[132:135], v[100:103], v[50:53]
    ds_read_b64_tr_b16 a[212:213], v76 offset:1024
    v_mfma_f32_16x16x32_bf16 v[204:207], v[128:131], v[100:103], v[54:57]
    ds_read_b64_tr_b16 a[214:215], v76 offset:512
    v_mfma_f32_16x16x32_bf16 v[168:171], v[136:139], v[104:107], v[50:53]
    ds_read_b64_tr_b16 a[216:217], v77 offset:1536
    v_mfma_f32_16x16x32_bf16 v[208:211], v[132:135], v[104:107], v[54:57]
    ds_read_b64_tr_b16 a[218:219], v77 offset:1024
    v_mfma_f32_16x16x32_bf16 v[172:175], v[140:143], v[108:111], v[50:53]
    ds_read_b64_tr_b16 a[220:221], v78 offset:2048
    s_add_u32 m0, s67, 103424
    v_mfma_f32_16x16x32_bf16 v[212:215], v[136:139], v[108:111], v[54:57]
    buffer_load_dwordx4 v27, s[56:59], s37 offen lds
    ds_read_b64_tr_b16 a[222:223], v78 offset:1536
    v_mfma_f32_16x16x32_bf16 v[176:179], v[144:147], v[112:115], v[50:53]
    ds_read_b64_tr_b16 a[224:225], v79 offset:512
    v_mfma_f32_16x16x32_bf16 v[240:243], v[192:195], v[112:115], v[62:65]
    ds_read_b64_tr_b16 a[226:227], v79 offset:0
    v_mfma_f32_16x16x32_bf16 v[180:183], v[148:151], v[116:119], v[50:53]
    ds_read_b64_tr_b16 a[228:229], v80 offset:1024
    v_mfma_f32_16x16x32_bf16 v[244:247], v[144:147], v[116:119], v[54:57]
    ds_read_b64_tr_b16 a[230:231], v80 offset:512
    v_mfma_f32_16x16x32_bf16 v[184:187], v[152:155], v[120:123], v[50:53]
    ds_read_b64_tr_b16 a[232:233], v81 offset:1536
    v_mfma_f32_16x16x32_bf16 v[248:251], v[148:151], v[120:123], v[54:57]
    ds_read_b64_tr_b16 a[234:235], v81 offset:1024
    v_mfma_f32_16x16x32_bf16 v[188:191], v[156:159], v[124:127], v[50:53]
    ds_read_b64_tr_b16 a[236:237], v82 offset:2048
    v_mfma_f32_16x16x32_bf16 v[252:255], v[152:155], v[124:127], v[54:57]
    ds_read_b64_tr_b16 a[238:239], v82 offset:1536
    s_mov_b32 s78, 1047616495
    s_mov_b32 s79, 1047616495
    s_mov_b32 s80, 1069066811
    s_mov_b32 s81, 1069066811
    v_readfirstlane_b32 s12, v88
    v_max_f32 v160, v160, v200
    v_max_f32 v161, v161, v201
    s_mov_b32 m0, s69
    v_max_f32 v162, v162, v202
    buffer_load_dwordx4 v28, s[44:47], s38 offen lds
    v_max_f32 v163, v163, v203
    v_max_f32 v164, v164, v204
    v_max_f32 v165, v165, v205
    v_max_f32 v166, v166, v206
    v_max_f32 v167, v167, v207
    v_max_f32 v168, v168, v208
    v_max_f32 v169, v169, v209
    v_max_f32 v170, v170, v210
    v_max_f32 v171, v171, v211
    v_max_f32 v172, v172, v212
    v_max_f32 v173, v173, v213
    v_max_f32 v174, v174, v214
    v_max_f32 v175, v175, v215
    v_max_f32 v176, v176, v240
    v_max_f32 v177, v177, v241
    v_max_f32 v178, v178, v242
    v_max_f32 v179, v179, v243
    v_max_f32 v180, v180, v244
    v_max_f32 v181, v181, v245
    v_max_f32 v182, v182, v246
    v_max_f32 v183, v183, v247
    v_max_f32 v184, v184, v248
    v_max_f32 v185, v185, v249
    v_max_f32 v186, v186, v250
    v_max_f32 v187, v187, v251
    v_max_f32 v188, v188, v252
    v_max_f32 v189, v189, v253
    v_max_f32 v190, v190, v254
    v_max_f32 v191, v191, v255
    v_cvt_pk_bf16_f32 v160, 0, v160
    v_cvt_pk_bf16_f32 v161, 0, v161
    v_cvt_pk_bf16_f32 v162, 0, v162
    v_cvt_pk_bf16_f32 v163, 0, v163
    v_cvt_pk_bf16_f32 v164, 0, v164
    v_cvt_pk_bf16_f32 v165, 0, v165
    v_cvt_pk_bf16_f32 v166, 0, v166
    v_cvt_pk_bf16_f32 v167, 0, v167
    s_add_u32 m0, s71, 109568
    v_cvt_pk_bf16_f32 v168, 0, v168
    buffer_load_dword v29, s[56:59], s37 offen lds
    v_cvt_pk_bf16_f32 v169, 0, v169
    v_cvt_pk_bf16_f32 v170, 0, v170
    v_cvt_pk_bf16_f32 v171, 0, v171
    v_cvt_pk_bf16_f32 v172, 0, v172
    v_cvt_pk_bf16_f32 v173, 0, v173
    v_cvt_pk_bf16_f32 v174, 0, v174
    v_cvt_pk_bf16_f32 v175, 0, v175
    v_cvt_pk_bf16_f32 v176, 0, v176
    v_cvt_pk_bf16_f32 v177, 0, v177
    v_cvt_pk_bf16_f32 v178, 0, v178
    v_cvt_pk_bf16_f32 v179, 0, v179
    v_cvt_pk_bf16_f32 v180, 0, v180
    v_cvt_pk_bf16_f32 v181, 0, v181
    v_cvt_pk_bf16_f32 v182, 0, v182
    v_cvt_pk_bf16_f32 v183, 0, v183
    v_cvt_pk_bf16_f32 v184, 0, v184
    v_cvt_pk_bf16_f32 v185, 0, v185
    v_cvt_pk_bf16_f32 v186, 0, v186
    v_cvt_pk_bf16_f32 v187, 0, v187
    v_cvt_pk_bf16_f32 v188, 0, v188
    v_cvt_pk_bf16_f32 v189, 0, v189
    v_cvt_pk_bf16_f32 v190, 0, v190
    v_cvt_pk_bf16_f32 v191, 0, v191
    v_pk_mul_f32 v[160:161], v[160:161], s[78:79]
    v_pk_mul_f32 v[162:163], v[162:163], s[78:79]
    v_pk_mul_f32 v[164:165], v[164:165], s[78:79]
    v_pk_mul_f32 v[166:167], v[166:167], s[78:79]
    v_pk_mul_f32 v[168:169], v[168:169], s[78:79]
    v_pk_mul_f32 v[170:171], v[170:171], s[78:79]
    v_pk_mul_f32 v[172:173], v[172:173], s[78:79]
    s_add_u32 m0, s67, 18432
    v_pk_mul_f32 v[174:175], v[174:175], s[78:79]
    buffer_load_dwordx4 v22, s[52:55], s36 offen lds
    v_pk_mul_f32 v[176:177], v[176:177], s[78:79]
    v_pk_mul_f32 v[178:179], v[178:179], s[78:79]
    v_pk_mul_f32 v[180:181], v[180:181], s[78:79]
    v_pk_mul_f32 v[182:183], v[182:183], s[78:79]
    v_pk_mul_f32 v[184:185], v[184:185], s[78:79]
    v_pk_mul_f32 v[186:187], v[186:187], s[78:79]
    v_pk_mul_f32 v[188:189], v[188:189], s[78:79]
    v_pk_mul_f32 v[190:191], v[190:191], s[78:79]
    v_cvt_pk_bf16_f32 v160, 0, v160
    v_cvt_pk_bf16_f32 v161, 0, v161
    v_cvt_pk_bf16_f32 v162, 0, v162
    v_cvt_pk_bf16_f32 v163, 0, v163
    v_cvt_pk_bf16_f32 v164, 0, v164
    v_cvt_pk_bf16_f32 v165, 0, v165
    v_cvt_pk_bf16_f32 v166, 0, v166
    v_cvt_pk_bf16_f32 v167, 0, v167
    v_cvt_pk_bf16_f32 v168, 0, v168
    v_cvt_pk_bf16_f32 v169, 0, v169
    v_cvt_pk_bf16_f32 v170, 0, v170
    v_cvt_pk_bf16_f32 v171, 0, v171
    v_cvt_pk_bf16_f32 v172, 0, v172
    v_cvt_pk_bf16_f32 v173, 0, v173
    v_cvt_pk_bf16_f32 v174, 0, v174
    v_cvt_pk_bf16_f32 v175, 0, v175
    v_cvt_pk_bf16_f32 v176, 0, v176
    v_cvt_pk_bf16_f32 v177, 0, v177
    v_cvt_pk_bf16_f32 v178, 0, v178
    v_cvt_pk_bf16_f32 v179, 0, v179
    s_add_u32 m0, s67, 22528
    v_cvt_pk_bf16_f32 v180, 0, v180
    buffer_load_dwordx4 v23, s[52:55], s36 offen lds
    v_cvt_pk_bf16_f32 v181, 0, v181
    v_cvt_pk_bf16_f32 v182, 0, v182
    v_cvt_pk_bf16_f32 v183, 0, v183
    v_cvt_pk_bf16_f32 v184, 0, v184
    v_cvt_pk_bf16_f32 v185, 0, v185
    v_cvt_pk_bf16_f32 v186, 0, v186
    v_cvt_pk_bf16_f32 v187, 0, v187
    v_cvt_pk_bf16_f32 v188, 0, v188
    v_cvt_pk_bf16_f32 v189, 0, v189
    v_cvt_pk_bf16_f32 v190, 0, v190
    v_cvt_pk_bf16_f32 v191, 0, v191
    v_max3_f32 v240, v160, v161, v162
    v_max3_f32 v241, v164, v165, v166
    v_max3_f32 v242, v168, v169, v170
    v_max3_f32 v243, v172, v173, v174
    v_max3_f32 v244, v176, v177, v178
    v_max3_f32 v245, v180, v181, v182
    v_max3_f32 v246, v184, v185, v186
    v_max3_f32 v247, v188, v189, v190
    v_max_f32 v240, v240, v163
    v_max_f32 v241, v241, v167
    v_max_f32 v242, v242, v171
    v_max_f32 v243, v243, v175
    v_max_f32 v244, v244, v179
    v_max_f32 v245, v245, v183
    v_max_f32 v246, v246, v187
    v_max_f32 v247, v247, v191
    v_permlane16_swap_b32 v240, v241
    v_permlane16_swap_b32 v244, v245
    v_permlane16_swap_b32 v242, v243
    v_permlane16_swap_b32 v246, v247
    v_max_f32 v240, v240, v241
    v_max_f32 v244, v244, v245
    v_max_f32 v242, v242, v243
    v_max_f32 v246, v246, v247
    s_nop 0
    v_permlane32_swap_b32 v240, v242
    v_permlane32_swap_b32 v244, v246
    s_add_u32 m0, s67, 26624
    v_max_f32 v248, v240, v242
    buffer_load_dwordx4 v24, s[52:55], s36 offen lds
    v_max_f32 v252, v244, v246
    v_mul_f32 v248, s80, v248
    v_mul_f32 v252, s80, v252
    v_mov_b32 v250, v248
    v_mov_b32 v254, v252
    s_nop 0
    v_permlane32_swap_b32 v248, v250
    v_permlane32_swap_b32 v252, v254
    v_mov_b32 v249, v248
    v_mov_b32 v253, v252
    v_mov_b32 v251, v250
    v_mov_b32 v255, v254
    v_permlane16_swap_b32 v248, v249
    v_permlane16_swap_b32 v252, v253
    v_permlane16_swap_b32 v250, v251
    v_permlane16_swap_b32 v254, v255
    s_waitcnt vmcnt(11)
    s_barrier
    v_pk_fma_f32 v[160:161], v[160:161], s[80:81], v[248:249] op_sel_hi:[1,1,0] neg_lo:[0,0,1] neg_hi:[0,0,1]
    v_pk_fma_f32 v[162:163], v[162:163], s[80:81], v[248:249] op_sel_hi:[1,1,0] neg_lo:[0,0,1] neg_hi:[0,0,1]
    v_pk_fma_f32 v[164:165], v[164:165], s[80:81], v[248:249] op_sel:[0,0,1] op_sel_hi:[1,1,1] neg_lo:[0,0,1] neg_hi:[0,0,1]
    v_pk_fma_f32 v[166:167], v[166:167], s[80:81], v[248:249] op_sel:[0,0,1] op_sel_hi:[1,1,1] neg_lo:[0,0,1] neg_hi:[0,0,1]
    v_pk_fma_f32 v[168:169], v[168:169], s[80:81], v[250:251] op_sel_hi:[1,1,0] neg_lo:[0,0,1] neg_hi:[0,0,1]
    v_pk_fma_f32 v[170:171], v[170:171], s[80:81], v[250:251] op_sel_hi:[1,1,0] neg_lo:[0,0,1] neg_hi:[0,0,1]
    v_pk_fma_f32 v[172:173], v[172:173], s[80:81], v[250:251] op_sel:[0,0,1] op_sel_hi:[1,1,1] neg_lo:[0,0,1] neg_hi:[0,0,1]
    v_pk_fma_f32 v[174:175], v[174:175], s[80:81], v[250:251] op_sel:[0,0,1] op_sel_hi:[1,1,1] neg_lo:[0,0,1] neg_hi:[0,0,1]
    v_pk_fma_f32 v[176:177], v[176:177], s[80:81], v[252:253] op_sel_hi:[1,1,0] neg_lo:[0,0,1] neg_hi:[0,0,1]
    v_pk_fma_f32 v[178:179], v[178:179], s[80:81], v[252:253] op_sel_hi:[1,1,0] neg_lo:[0,0,1] neg_hi:[0,0,1]
    v_pk_fma_f32 v[180:181], v[180:181], s[80:81], v[252:253] op_sel:[0,0,1] op_sel_hi:[1,1,1] neg_lo:[0,0,1] neg_hi:[0,0,1]
    s_add_u32 m0, s67, 30720
    v_pk_fma_f32 v[182:183], v[182:183], s[80:81], v[252:253] op_sel:[0,0,1] op_sel_hi:[1,1,1] neg_lo:[0,0,1] neg_hi:[0,0,1]
    buffer_load_dwordx4 v25, s[52:55], s36 offen lds
    v_pk_fma_f32 v[184:185], v[184:185], s[80:81], v[254:255] op_sel_hi:[1,1,0] neg_lo:[0,0,1] neg_hi:[0,0,1]
    v_pk_fma_f32 v[186:187], v[186:187], s[80:81], v[254:255] op_sel_hi:[1,1,0] neg_lo:[0,0,1] neg_hi:[0,0,1]
    v_pk_fma_f32 v[188:189], v[188:189], s[80:81], v[254:255] op_sel:[0,0,1] op_sel_hi:[1,1,1] neg_lo:[0,0,1] neg_hi:[0,0,1]
    v_pk_fma_f32 v[190:191], v[190:191], s[80:81], v[254:255] op_sel:[0,0,1] op_sel_hi:[1,1,1] neg_lo:[0,0,1] neg_hi:[0,0,1]
    v_exp_f32 v160, v160
    ds_read_b64_tr_b16 a[0:1], v93 offset:0
    ds_read_b64_tr_b16 a[2:3], v93 offset:144
    v_exp_f32 v161, v161
    ds_read_b64_tr_b16 a[4:5], v93 offset:32
    ds_read_b64_tr_b16 a[6:7], v93 offset:176
    v_exp_f32 v162, v162
    ds_read_b64_tr_b16 a[8:9], v93 offset:64
    ds_read_b64_tr_b16 a[10:11], v93 offset:208
    v_exp_f32 v163, v163
    ds_read_b64_tr_b16 a[12:13], v93 offset:96
    ds_read_b64_tr_b16 a[14:15], v93 offset:240
    v_exp_f32 v164, v164
    ds_read_b64_tr_b16 a[16:17], v93 offset:128
    ds_read_b64_tr_b16 a[18:19], v93 offset:272
    v_exp_f32 v165, v165
    ds_read_b64_tr_b16 a[20:21], v93 offset:4608
    ds_read_b64_tr_b16 a[22:23], v93 offset:4752
    v_exp_f32 v166, v166
    ds_read_b64_tr_b16 a[24:25], v93 offset:4640
    ds_read_b64_tr_b16 a[26:27], v93 offset:4784
    s_add_u32 m0, s67, 110592
    v_exp_f32 v167, v167
    buffer_load_dwordx4 v22, s[56:59], s40 offen lds
    ds_read_b64_tr_b16 a[28:29], v93 offset:4672
    ds_read_b64_tr_b16 a[30:31], v93 offset:4816
    v_exp_f32 v168, v168
    ds_read_b64_tr_b16 a[32:33], v93 offset:4704
    ds_read_b64_tr_b16 a[34:35], v93 offset:4848
    v_exp_f32 v169, v169
    ds_read_b64_tr_b16 a[36:37], v93 offset:4736
    ds_read_b64_tr_b16 a[38:39], v93 offset:4880
    v_exp_f32 v170, v170
    ds_read_b64_tr_b16 a[40:41], v93 offset:9216
    ds_read_b64_tr_b16 a[42:43], v93 offset:9360
    v_exp_f32 v171, v171
    ds_read_b64_tr_b16 a[44:45], v93 offset:9248
    ds_read_b64_tr_b16 a[46:47], v93 offset:9392
    v_exp_f32 v172, v172
    ds_read_b64_tr_b16 a[48:49], v93 offset:9280
    ds_read_b64_tr_b16 a[50:51], v93 offset:9424
    v_exp_f32 v173, v173
    ds_read_b64_tr_b16 a[52:53], v93 offset:9312
    ds_read_b64_tr_b16 a[54:55], v93 offset:9456
    v_exp_f32 v174, v174
    ds_read_b64_tr_b16 a[56:57], v93 offset:9344
    ds_read_b64_tr_b16 a[58:59], v93 offset:9488
    v_exp_f32 v175, v175
    ds_read_b64_tr_b16 a[60:61], v93 offset:13824
    ds_read_b64_tr_b16 a[62:63], v93 offset:13968
    v_exp_f32 v176, v176
    ds_read_b64_tr_b16 a[64:65], v93 offset:13856
    ds_read_b64_tr_b16 a[66:67], v93 offset:14000
    s_add_u32 m0, s67, 114688
    v_exp_f32 v177, v177
    buffer_load_dwordx4 v23, s[56:59], s40 offen lds
    ds_read_b64_tr_b16 a[68:69], v93 offset:13888
    ds_read_b64_tr_b16 a[70:71], v93 offset:14032
    v_exp_f32 v178, v178
    ds_read_b64_tr_b16 a[72:73], v93 offset:13920
    ds_read_b64_tr_b16 a[74:75], v93 offset:14064
    v_exp_f32 v179, v179
    ds_read_b64_tr_b16 a[76:77], v93 offset:13952
    ds_read_b64_tr_b16 a[78:79], v93 offset:14096
    v_exp_f32 v180, v180
    ds_read_b64_tr_b16 a[80:81], v93 offset:18432
    ds_read_b64_tr_b16 a[82:83], v93 offset:18576
    v_exp_f32 v181, v181
    ds_read_b64_tr_b16 a[84:85], v93 offset:18464
    ds_read_b64_tr_b16 a[86:87], v93 offset:18608
    v_exp_f32 v182, v182
    ds_read_b64_tr_b16 a[88:89], v93 offset:18496
    ds_read_b64_tr_b16 a[90:91], v93 offset:18640
    v_exp_f32 v183, v183
    ds_read_b64_tr_b16 a[92:93], v93 offset:18528
    ds_read_b64_tr_b16 a[94:95], v93 offset:18672
    v_exp_f32 v184, v184
    ds_read_b64_tr_b16 a[96:97], v93 offset:18560
    ds_read_b64_tr_b16 a[98:99], v93 offset:18704
    v_exp_f32 v185, v185
    ds_read_b64_tr_b16 a[100:101], v93 offset:23040
    ds_read_b64_tr_b16 a[102:103], v93 offset:23184
    v_exp_f32 v186, v186
    ds_read_b64_tr_b16 a[104:105], v93 offset:23072
    ds_read_b64_tr_b16 a[106:107], v93 offset:23216
    s_add_u32 m0, s67, 118784
    v_exp_f32 v187, v187
    buffer_load_dwordx4 v24, s[56:59], s40 offen lds
    ds_read_b64_tr_b16 a[108:109], v93 offset:23104
    ds_read_b64_tr_b16 a[110:111], v93 offset:23248
    v_exp_f32 v188, v188
    ds_read_b64_tr_b16 a[112:113], v93 offset:23136
    s_branch .Lsk4
.Lpad4:
    s_branch .Lpret
.Lsk4:
    ds_read_b64_tr_b16 a[114:115], v93 offset:23280
    v_exp_f32 v189, v189
    ds_read_b64_tr_b16 a[116:117], v93 offset:23168
    ds_read_b64_tr_b16 a[118:119], v93 offset:23312
    v_exp_f32 v190, v190
    v_exp_f32 v191, v191
    v_pk_add_f32 v[200:201], v[160:161], v[162:163]
    v_pk_add_f32 v[202:203], v[164:165], v[166:167]
    v_pk_add_f32 v[204:205], v[168:169], v[170:171]
    v_pk_add_f32 v[206:207], v[172:173], v[174:175]
    v_pk_add_f32 v[208:209], v[176:177], v[178:179]
    v_pk_add_f32 v[210:211], v[180:181], v[182:183]
    v_pk_add_f32 v[212:213], v[184:185], v[186:187]
    v_pk_add_f32 v[214:215], v[188:189], v[190:191]
    v_add_f32 v240, v200, v201
    v_add_f32 v241, v202, v203
    s_add_u32 m0, s67, 122880
    v_add_f32 v242, v204, v205
    buffer_load_dwordx4 v25, s[56:59], s40 offen lds
    v_add_f32 v243, v206, v207
    v_add_f32 v244, v208, v209
    v_add_f32 v245, v210, v211
    v_add_f32 v246, v212, v213
    v_add_f32 v247, v214, v215
    v_permlane16_swap_b32 v240, v241
    v_permlane16_swap_b32 v244, v245
    v_permlane16_swap_b32 v242, v243
    v_permlane16_swap_b32 v246, v247
    v_add_f32 v240, v240, v241
    v_add_f32 v244, v244, v245
    v_add_f32 v242, v242, v243
    v_add_f32 v246, v246, v247
    s_nop 0
    v_permlane32_swap_b32 v240, v242
    v_permlane32_swap_b32 v244, v246
    v_add_f32 v248, v240, v242
    v_add_f32 v252, v244, v246
    v_rcp_f32 v248, v248
    v_rcp_f32 v252, v252
    v_mov_b32 v250, v248
    v_mov_b32 v254, v252
    s_nop 0
    v_permlane32_swap_b32 v248, v250
    v_permlane32_swap_b32 v252, v254
    v_mov_b32 v249, v248
    v_mov_b32 v253, v252
    v_mov_b32 v251, v250
    v_mov_b32 v255, v254
    v_permlane16_swap_b32 v248, v249
    v_permlane16_swap_b32 v252, v253
    v_permlane16_swap_b32 v250, v251
    v_permlane16_swap_b32 v254, v255
    s_add_u32 m0, s67, 126976
    v_pk_mul_f32 v[160:161], v[160:161], v[248:249] op_sel_hi:[1,0]
    buffer_load_dwordx4 v32, s[56:59], 0 offen lds
    v_pk_mul_f32 v[162:163], v[162:163], v[248:249] op_sel_hi:[1,0]
    v_pk_mul_f32 v[164:165], v[164:165], v[248:249] op_sel:[0,1] op_sel_hi:[1,1]
    v_pk_mul_f32 v[166:167], v[166:167], v[248:249] op_sel:[0,1] op_sel_hi:[1,1]
    v_pk_mul_f32 v[168:169], v[168:169], v[250:251] op_sel_hi:[1,0]
    v_pk_mul_f32 v[170:171], v[170:171], v[250:251] op_sel_hi:[1,0]
    v_pk_mul_f32 v[172:173], v[172:173], v[250:251] op_sel:[0,1] op_sel_hi:[1,1]
    v_pk_mul_f32 v[174:175], v[174:175], v[250:251] op_sel:[0,1] op_sel_hi:[1,1]
    v_pk_mul_f32 v[176:177], v[176:177], v[252:253] op_sel_hi:[1,0]
    v_pk_mul_f32 v[178:179], v[178:179], v[252:253] op_sel_hi:[1,0]
    v_pk_mul_f32 v[180:181], v[180:181], v[252:253] op_sel:[0,1] op_sel_hi:[1,1]
    v_pk_mul_f32 v[182:183], v[182:183], v[252:253] op_sel:[0,1] op_sel_hi:[1,1]
    v_pk_mul_f32 v[184:185], v[184:185], v[254:255] op_sel_hi:[1,0]
    v_pk_mul_f32 v[186:187], v[186:187], v[254:255] op_sel_hi:[1,0]
    v_pk_mul_f32 v[188:189], v[188:189], v[254:255] op_sel:[0,1] op_sel_hi:[1,1]
    v_pk_mul_f32 v[190:191], v[190:191], v[254:255] op_sel:[0,1] op_sel_hi:[1,1]
    s_add_u32 m0, s67, 131072
    v_cvt_pk_bf16_f32 v200, v160, v161
    buffer_load_dwordx4 v33, s[56:59], 0 offen lds
    s_mov_b32 m0, s70
    v_cvt_pk_bf16_f32 v201, v162, v163
    buffer_load_dwordx4 v95, s[44:47], s41 offen lds
    s_add_u32 m0, s71, 137216
    v_cvt_pk_bf16_f32 v202, v164, v165
    buffer_load_dword v35, s[56:59], 0 offen lds
    s_add_u32 m0, s67, 36864
    v_cvt_pk_bf16_f32 v203, v166, v167
    buffer_load_dwordx4 v22, s[52:55], s39 offen lds
    s_add_u32 m0, s67, 40960
    v_cvt_pk_bf16_f32 v204, v168, v169
    buffer_load_dwordx4 v23, s[52:55], s39 offen lds
    s_add_u32 m0, s67, 45056
    v_cvt_pk_bf16_f32 v205, v170, v171
    buffer_load_dwordx4 v24, s[52:55], s39 offen lds
    s_add_u32 m0, s67, 49152
    v_cvt_pk_bf16_f32 v206, v172, v173
    buffer_load_dwordx4 v25, s[52:55], s39 offen lds
    v_cvt_pk_bf16_f32 v207, v174, v175
    v_cvt_pk_bf16_f32 v208, v176, v177
    v_cvt_pk_bf16_f32 v209, v178, v179
    v_cvt_pk_bf16_f32 v210, v180, v181
    v_cvt_pk_bf16_f32 v211, v182, v183
    v_cvt_pk_bf16_f32 v212, v184, v185
    v_cvt_pk_bf16_f32 v213, v186, v187
    v_cvt_pk_bf16_f32 v214, v188, v189
    v_cvt_pk_bf16_f32 v215, v190, v191
    s_waitcnt lgkmcnt(0)
    v_and_b32 v96, v66, v200
    v_and_b32 v97, v67, v201
    v_and_b32 v98, v68, v200
    v_and_b32 v99, v69, v201
    v_and_b32 v100, v66, v202
    v_and_b32 v101, v67, v203
    v_and_b32 v102, v68, v202
    v_and_b32 v103, v69, v203
    v_mfma_f32_16x16x32_bf16 v[128:131], v[226:229], v[96:99], 0
    v_and_b32 v104, v66, v204
    v_and_b32 v105, v67, v205
    v_and_b32 v106, v68, v204
    v_and_b32 v107, v69, v205
    v_mfma_f32_16x16x32_bf16 v[132:135], v[224:227], v[100:103], 0
    v_and_b32 v108, v66, v206
    v_and_b32 v109, v67, v207
    v_and_b32 v110, v68, v206
    v_and_b32 v111, v69, v207
    v_mfma_f32_16x16x32_bf16 v[136:139], v[222:225], v[104:107], 0
    v_and_b32 v112, v66, v208
    v_and_b32 v113, v67, v209
    v_and_b32 v114, v68, v208
    v_and_b32 v115, v69, v209
    v_mfma_f32_16x16x32_bf16 v[140:143], v[220:223], v[108:111], 0
    v_and_b32 v116, v66, v210
    v_and_b32 v117, v67, v211
    v_and_b32 v118, v68, v210
    v_and_b32 v119, v69, v211
    v_mfma_f32_16x16x32_bf16 v[144:147], v[236:239], v[112:115], 0
    v_and_b32 v120, v66, v212
    v_and_b32 v121, v67, v213
    v_and_b32 v122, v68, v212
    v_and_b32 v123, v69, v213
    v_mfma_f32_16x16x32_bf16 v[148:151], v[234:237], v[116:119], 0
    v_and_b32 v124, v66, v214
    v_and_b32 v125, v67, v215
    v_and_b32 v126, v68, v214
    v_and_b32 v127, v69, v215
    v_mfma_f32_16x16x32_bf16 v[152:155], v[232:235], v[120:123], 0
    s_nop 0
    v_mfma_f32_16x16x32_bf16 v[156:159], v[230:233], v[124:127], 0
    v_mfma_f32_16x16x32_bf16 v[192:195], a[208:211], v[96:99], 0
    v_cvt_pk_bf16_f32 v200, v128, v129
    v_cvt_pk_bf16_f32 v201, v130, v131
    v_mfma_f32_16x16x32_bf16 v[192:195], a[212:215], v[100:103], v[192:195]
    v_cvt_pk_bf16_f32 v202, v132, v133
    v_cvt_pk_bf16_f32 v203, v134, v135
    v_mfma_f32_16x16x32_bf16 v[192:195], a[216:219], v[104:107], v[192:195]
    v_cvt_pk_bf16_f32 v204, v136, v137
    v_cvt_pk_bf16_f32 v205, v138, v139
    v_mfma_f32_16x16x32_bf16 v[192:195], a[220:223], v[108:111], v[192:195]
    v_cvt_pk_bf16_f32 v206, v140, v141
    v_cvt_pk_bf16_f32 v207, v142, v143
    v_mfma_f32_16x16x32_bf16 v[196:199], a[224:227], v[112:115], 0
    v_cvt_pk_bf16_f32 v208, v144, v145
    v_cvt_pk_bf16_f32 v209, v146, v147
    v_mfma_f32_16x16x32_bf16 v[196:199], a[228:231], v[116:119], v[196:199]
    v_cvt_pk_bf16_f32 v210, v148, v149
    v_cvt_pk_bf16_f32 v211, v150, v151
    v_mfma_f32_16x16x32_bf16 v[196:199], a[232:235], v[120:123], v[196:199]
    v_cvt_pk_bf16_f32 v212, v152, v153
    v_cvt_pk_bf16_f32 v213, v154, v155
    v_mfma_f32_16x16x32_bf16 v[196:199], a[236:239], v[124:127], v[196:199]
    v_cvt_pk_bf16_f32 v214, v156, v157
    v_cvt_pk_bf16_f32 v215, v158, v159
    s_mov_b32 s74, 36864
    s_cmp_eq_u32 s100, 1
    s_cselect_b64 vcc, -1, 0
    v_permlane16_swap_b32 v200, v202
    v_permlane16_swap_b32 v201, v203
    v_permlane16_swap_b32 v204, v206
    v_permlane16_swap_b32 v205, v207
    v_permlane16_swap_b32 v208, v210
    v_permlane16_swap_b32 v209, v211
    v_permlane16_swap_b32 v212, v214
    v_permlane16_swap_b32 v213, v215
    v_cvt_pk_bf16_f32 v216, v192, v193
    v_cvt_pk_bf16_f32 v218, v194, v195
    v_cvt_pk_bf16_f32 v217, v196, v197
    v_cvt_pk_bf16_f32 v219, v198, v199
    v_cndmask_b32 v216, v216, v218, vcc
    v_cndmask_b32 v217, v217, v219, vcc
    s_bitcmp1_b32 s12, 1
    s_cbranch_scc0 .slow_15
    buffer_store_dwordx4 v[200:203], v83, s[48:51], 0 offen sc1
    buffer_store_dwordx4 v[204:207], v83, s[48:51], s74 offen sc1
    buffer_store_dwordx4 v[208:211], v84, s[48:51], 0 offen sc1
    buffer_store_dwordx4 v[212:215], v84, s[48:51], s74 offen sc1
    buffer_store_dword v216, v85, s[48:51], 0 offen
    buffer_store_dword v217, v86, s[48:51], 0 offen
    s_branch .sdone_16
.slow_15:
    buffer_store_dwordx4 v[200:203], v83, s[48:51], 0 offen sc1
    buffer_store_dwordx4 v[204:207], v83, s[48:51], s74 offen sc1
    buffer_store_dwordx4 v[208:211], v84, s[48:51], 0 offen sc1
    buffer_store_dwordx4 v[212:215], v84, s[48:51], s74 offen sc1
    buffer_store_dword v216, v85, s[48:51], 0 offen sc1
    buffer_store_dword v217, v86, s[48:51], 0 offen sc1
.sdone_16:
    s_and_b32 s73, s5, 1
    s_lshl_b32 s73, s73, 8
    s_lshl_b32 s72, s7, 4
    s_add_u32 s73, s73, s72
    s_lshl_b32 s72, s3, 2
    s_add_u32 s73, s73, s72
    v_add_u32 v6, s73, v89
    s_lshl_b32 s73, s6, 2
    v_mov_b32 v7, s73
    v_mov_b32 v8, 4
    s_bfe_u32 s73, s5, 0x10001
    s_lshl_b32 s72, s73, 8
    s_lshl_b32 s74, s4, 10
    s_add_u32 s72, s72, s74
    s_add_u32 s72, s72, 4727040
    v_lshlrev_b32 v9, 2, v1
    v_add_u32 v10, s72, v9
    s_lshl_b32 s72, s4, 1
    s_add_u32 s72, s72, s73
    s_lshl_b32 s73, s72, 2
    v_mov_b32 v11, s73
    s_and_b32 s73, s5, 3
    s_lshl_b32 s73, s73, 2
    s_lshl_b32 s72, s4, 4
    s_add_u32 s72, s72, s73
    s_lshr_b32 s8, s3, 1
    s_and_b32 s9, s3, 1
    s_lshl_b32 s73, s9, 1
    s_add_u32 s72, s72, s73
    s_add_u32 s6, s72, s8
    s_xor_b32 s7, s6, 1
    v_lshlrev_b32 v9, 4, v1
    s_mul_i32 s73, s8, 2359296
    s_mul_i32 s72, s6, 18432
    s_add_u32 s72, s72, s73
    v_add_u32 v82, s72, v9
    s_mul_i32 s72, s7, 18432
    s_add_u32 s72, s72, s73
    v_add_u32 v83, s72, v9
    s_movk_i32 s78, 4096
    s_movk_i32 s79, 8192
    s_movk_i32 s80, 12288
    s_movk_i32 s81, 16384
    v_lshlrev_b32 v84, 2, v3
    v_add_u32 v84, 4718592, v84
    s_mov_b32 s101, 0
    s_mov_b64 exec, 1
    s_bitcmp1_b32 s12, 1
    s_waitcnt vmcnt(0)
    s_cbranch_scc0 .noflag2_18
    global_store_dword v6, v92, s[34:35] offset:256
.noflag2_18:
    s_barrier
    s_and_b32 s72, s12, 2
    s_or_b32 s72, s72, s3
    s_cbranch_scc1 .noflag_17
    global_atomic_add v7, v8, s[32:33] sc1
.noflag_17:
    s_mov_b64 exec, -1
    v_mov_b32 v12, 0
    v_mov_b32 v13, 0
    s_bitcmp1_b32 s12, 0
    s_cbranch_scc0 .pf_21
    global_load_dword v12, v10, s[34:35] sc1
.pf_21:
    s_bitcmp1_b32 s12, 1
    s_cbranch_scc1 .pf_22
    global_load_dword v13, v11, s[32:33] sc1
.pf_22:
.c_19:
    s_cmp_eq_u32 s8, 0
    s_cbranch_scc0 .na_23
    ds_read_b64_tr_b16 a[80:81], v93 offset:18432
    ds_read_b64_tr_b16 a[82:83], v93 offset:18576
    ds_read_b64_tr_b16 a[84:85], v93 offset:18464
    ds_read_b64_tr_b16 a[86:87], v93 offset:18608
    ds_read_b64_tr_b16 a[88:89], v93 offset:18496
    ds_read_b64_tr_b16 a[90:91], v93 offset:18640
    ds_read_b64_tr_b16 a[92:93], v93 offset:18528
    ds_read_b64_tr_b16 a[94:95], v93 offset:18672
    ds_read_b64_tr_b16 a[96:97], v93 offset:18560
    ds_read_b64_tr_b16 a[98:99], v93 offset:18704
    ds_read_b64_tr_b16 a[100:101], v93 offset:23040
    ds_read_b64_tr_b16 a[102:103], v93 offset:23184
    ds_read_b64_tr_b16 a[104:105], v93 offset:23072
    ds_read_b64_tr_b16 a[106:107], v93 offset:23216
    ds_read_b64_tr_b16 a[108:109], v93 offset:23104
    ds_read_b64_tr_b16 a[110:111], v93 offset:23248
    ds_read_b64_tr_b16 a[112:113], v93 offset:23136
    ds_read_b64_tr_b16 a[114:115], v93 offset:23280
    ds_read_b64_tr_b16 a[116:117], v93 offset:23168
    ds_read_b64_tr_b16 a[118:119], v93 offset:23312
.na_23:
    ds_read_b64_tr_b16 a[120:121], v93 offset:27648
    ds_read_b64_tr_b16 a[122:123], v93 offset:27792
    ds_read_b64_tr_b16 a[124:125], v93 offset:27680
    ds_read_b64_tr_b16 a[126:127], v93 offset:27824
    ds_read_b64_tr_b16 a[128:129], v93 offset:27712
    ds_read_b64_tr_b16 a[130:131], v93 offset:27856
    ds_read_b64_tr_b16 a[132:133], v93 offset:27744
    ds_read_b64_tr_b16 a[134:135], v93 offset:27888
    ds_read_b64_tr_b16 a[136:137], v93 offset:27776
    ds_read_b64_tr_b16 a[138:139], v93 offset:27920
    ds_read_b64_tr_b16 a[140:141], v93 offset:32256
    ds_read_b64_tr_b16 a[142:143], v93 offset:32400
    ds_read_b64_tr_b16 a[144:145], v93 offset:32288
    ds_read_b64_tr_b16 a[146:147], v93 offset:32432
    ds_read_b64_tr_b16 a[148:149], v93 offset:32320
    ds_read_b64_tr_b16 a[150:151], v93 offset:32464
    ds_read_b64_tr_b16 a[152:153], v93 offset:32352
    ds_read_b64_tr_b16 a[154:155], v93 offset:32496
    ds_read_b64_tr_b16 a[156:157], v93 offset:32384
    ds_read_b64_tr_b16 a[158:159], v93 offset:32528
    s_waitcnt vmcnt(0)
    v_cmp_eq_u32 vcc, 1, v12
    v_readfirstlane_b32 s73, v13
    s_bcnt1_i32_b64 s72, vcc
    s_add_u32 s72, s72, s73
    s_cmp_eq_u32 s72, 64
    s_cbranch_scc0 .c_20
    buffer_load_dwordx4 v[168:171], v83, s[48:51], 0 offen offset:0
    buffer_load_dwordx4 v[172:175], v83, s[48:51], 0 offen offset:1024
    buffer_load_dwordx4 v[176:179], v83, s[48:51], 0 offen offset:2048
    buffer_load_dwordx4 v[96:99], v82, s[48:51], 0 offen offset:0
    buffer_load_dwordx4 v[180:183], v83, s[48:51], 0 offen offset:3072
    buffer_load_dwordx4 v[100:103], v82, s[48:51], 0 offen offset:1024
    buffer_load_dwordx4 v[184:187], v83, s[48:51], s78 offen offset:0
    buffer_load_dwordx4 v[104:107], v82, s[48:51], 0 offen offset:2048
    buffer_load_dwordx4 v[188:191], v83, s[48:51], s78 offen offset:1024
    buffer_load_dwordx4 v[108:111], v82, s[48:51], 0 offen offset:3072
    buffer_load_dwordx4 v[192:195], v83, s[48:51], s78 offen offset:2048
    buffer_load_dwordx4 v[112:115], v82, s[48:51], s78 offen offset:0
    s_mov_b32 s101, 1
.c_20:
    s_cmp_eq_u32 s101, 0
    s_cbranch_scc0 .c_24
    v_mov_b32 v12, 0
    v_mov_b32 v13, 0
    s_bitcmp1_b32 s12, 0
    s_cbranch_scc0 .pf_26
    global_load_dword v12, v10, s[34:35] sc1
.pf_26:
    s_bitcmp1_b32 s12, 1
    s_cbranch_scc1 .pf_27
    global_load_dword v13, v11, s[32:33] sc1
.pf_27:
.c_24:
    ds_read_b64_tr_b16 a[160:161], v93 offset:36864
    ds_read_b64_tr_b16 a[162:163], v93 offset:37008
    ds_read_b64_tr_b16 a[164:165], v93 offset:36896
    ds_read_b64_tr_b16 a[166:167], v93 offset:37040
    ds_read_b64_tr_b16 a[168:169], v93 offset:36928
    ds_read_b64_tr_b16 a[170:171], v93 offset:37072
    ds_read_b64_tr_b16 a[172:173], v93 offset:36960
    ds_read_b64_tr_b16 a[174:175], v93 offset:37104
    ds_read_b64_tr_b16 a[176:177], v93 offset:36992
    ds_read_b64_tr_b16 a[178:179], v93 offset:37136
    ds_read_b64_tr_b16 a[180:181], v94 offset:0
    ds_read_b64_tr_b16 a[182:183], v94 offset:144
    ds_read_b64_tr_b16 a[184:185], v94 offset:32
    ds_read_b64_tr_b16 a[186:187], v94 offset:176
    ds_read_b64_tr_b16 a[188:189], v94 offset:64
    ds_read_b64_tr_b16 a[190:191], v94 offset:208
    ds_read_b64_tr_b16 a[192:193], v94 offset:96
    ds_read_b64_tr_b16 a[194:195], v94 offset:240
    ds_read_b64_tr_b16 a[196:197], v94 offset:128
    ds_read_b64_tr_b16 a[198:199], v94 offset:272
    s_cmp_eq_u32 s101, 0
    s_cbranch_scc0 .c_25
    s_waitcnt vmcnt(0)
    v_cmp_eq_u32 vcc, 1, v12
    v_readfirstlane_b32 s73, v13
    s_bcnt1_i32_b64 s72, vcc
    s_add_u32 s72, s72, s73
    s_cmp_eq_u32 s72, 64
    s_cbranch_scc0 .c_25
    buffer_load_dwordx4 v[168:171], v83, s[48:51], 0 offen offset:0
    buffer_load_dwordx4 v[172:175], v83, s[48:51], 0 offen offset:1024
    buffer_load_dwordx4 v[176:179], v83, s[48:51], 0 offen offset:2048
    buffer_load_dwordx4 v[96:99], v82, s[48:51], 0 offen offset:0
    buffer_load_dwordx4 v[180:183], v83, s[48:51], 0 offen offset:3072
    buffer_load_dwordx4 v[100:103], v82, s[48:51], 0 offen offset:1024
    buffer_load_dwordx4 v[184:187], v83, s[48:51], s78 offen offset:0
    buffer_load_dwordx4 v[104:107], v82, s[48:51], 0 offen offset:2048
    buffer_load_dwordx4 v[188:191], v83, s[48:51], s78 offen offset:1024
    buffer_load_dwordx4 v[108:111], v82, s[48:51], 0 offen offset:3072
    buffer_load_dwordx4 v[192:195], v83, s[48:51], s78 offen offset:2048
    buffer_load_dwordx4 v[112:115], v82, s[48:51], s78 offen offset:0
    s_mov_b32 s101, 1
.c_25:
    s_cmp_eq_u32 s101, 0
    s_cbranch_scc0 .c_28
    v_mov_b32 v12, 0
    v_mov_b32 v13, 0
    s_bitcmp1_b32 s12, 0
    s_cbranch_scc0 .pf_30
    global_load_dword v12, v10, s[34:35] sc1
.pf_30:
    s_bitcmp1_b32 s12, 1
    s_cbranch_scc1 .pf_31
    global_load_dword v13, v11, s[32:33] sc1
.pf_31:
.c_28:
    ds_read_b64_tr_b16 a[200:201], v94 offset:4608
    ds_read_b64_tr_b16 a[202:203], v94 offset:4752
    ds_read_b64_tr_b16 a[204:205], v94 offset:4640
    ds_read_b64_tr_b16 a[206:207], v94 offset:4784
    ds_read_b64_tr_b16 a[208:209], v94 offset:4672
    ds_read_b64_tr_b16 a[210:211], v94 offset:4816
    ds_read_b64_tr_b16 a[212:213], v94 offset:4704
    ds_read_b64_tr_b16 a[214:215], v94 offset:4848
    ds_read_b64_tr_b16 a[216:217], v94 offset:4736
    ds_read_b64_tr_b16 a[218:219], v94 offset:4880
    ds_read_b64_tr_b16 a[220:221], v94 offset:9216
    ds_read_b64_tr_b16 a[222:223], v94 offset:9360
    ds_read_b64_tr_b16 a[224:225], v94 offset:9248
    ds_read_b64_tr_b16 a[226:227], v94 offset:9392
    ds_read_b64_tr_b16 a[228:229], v94 offset:9280
    ds_read_b64_tr_b16 a[230:231], v94 offset:9424
    ds_read_b64_tr_b16 a[232:233], v94 offset:9312
    ds_read_b64_tr_b16 a[234:235], v94 offset:9456
    ds_read_b64_tr_b16 a[236:237], v94 offset:9344
    ds_read_b64_tr_b16 a[238:239], v94 offset:9488
    s_cmp_eq_u32 s101, 0
    s_cbranch_scc0 .c_29
    s_waitcnt vmcnt(0)
    v_cmp_eq_u32 vcc, 1, v12
    v_readfirstlane_b32 s73, v13
    s_bcnt1_i32_b64 s72, vcc
    s_add_u32 s72, s72, s73
    s_cmp_eq_u32 s72, 64
    s_cbranch_scc0 .c_29
    buffer_load_dwordx4 v[168:171], v83, s[48:51], 0 offen offset:0
    buffer_load_dwordx4 v[172:175], v83, s[48:51], 0 offen offset:1024
    buffer_load_dwordx4 v[176:179], v83, s[48:51], 0 offen offset:2048
    buffer_load_dwordx4 v[96:99], v82, s[48:51], 0 offen offset:0
    buffer_load_dwordx4 v[180:183], v83, s[48:51], 0 offen offset:3072
    buffer_load_dwordx4 v[100:103], v82, s[48:51], 0 offen offset:1024
    buffer_load_dwordx4 v[184:187], v83, s[48:51], s78 offen offset:0
    buffer_load_dwordx4 v[104:107], v82, s[48:51], 0 offen offset:2048
    buffer_load_dwordx4 v[188:191], v83, s[48:51], s78 offen offset:1024
    buffer_load_dwordx4 v[108:111], v82, s[48:51], 0 offen offset:3072
    buffer_load_dwordx4 v[192:195], v83, s[48:51], s78 offen offset:2048
    buffer_load_dwordx4 v[112:115], v82, s[48:51], s78 offen offset:0
    s_mov_b32 s101, 1
.c_29:
    s_cmp_eq_u32 s101, 0
    s_cbranch_scc0 .go_34
    s_mov_b32 s74, 0
.poll_32:
    v_mov_b32 v12, 0
    v_mov_b32 v13, 0
    s_bitcmp1_b32 s12, 0
    s_cbranch_scc0 .pf_35
    global_load_dword v12, v10, s[34:35] sc1
.pf_35:
    s_bitcmp1_b32 s12, 1
    s_cbranch_scc1 .pf_36
    global_load_dword v13, v11, s[32:33] sc1
.pf_36:
    s_add_u32 s74, s74, 1
    s_cmp_eq_u32 s74, 24
    s_cselect_b32 s72, 2, 0
    s_andn2_b32 s12, s12, s72
    s_waitcnt vmcnt(0)
    v_cmp_eq_u32 vcc, 1, v12
    v_readfirstlane_b32 s73, v13
    s_bcnt1_i32_b64 s72, vcc
    s_add_u32 s72, s72, s73
    s_cmp_eq_u32 s72, 64
    s_cbranch_scc1 .go_33
    s_cmp_lt_u32 s74, 0x4000
    s_cbranch_scc1 .poll_32
.go_33:
    buffer_load_dwordx4 v[168:171], v83, s[48:51], 0 offen offset:0
    buffer_load_dwordx4 v[172:175], v83, s[48:51], 0 offen offset:1024
    buffer_load_dwordx4 v[176:179], v83, s[48:51], 0 offen offset:2048
    buffer_load_dwordx4 v[96:99], v82, s[48:51], 0 offen offset:0
    buffer_load_dwordx4 v[180:183], v83, s[48:51], 0 offen offset:3072
    buffer_load_dwordx4 v[100:103], v82, s[48:51], 0 offen offset:1024
    buffer_load_dwordx4 v[184:187], v83, s[48:51], s78 offen offset:0
    buffer_load_dwordx4 v[104:107], v82, s[48:51], 0 offen offset:2048
    buffer_load_dwordx4 v[188:191], v83, s[48:51], s78 offen offset:1024
    buffer_load_dwordx4 v[108:111], v82, s[48:51], 0 offen offset:3072
    buffer_load_dwordx4 v[192:195], v83, s[48:51], s78 offen offset:2048
    buffer_load_dwordx4 v[112:115], v82, s[48:51], s78 offen offset:0
.go_34:
    s_waitcnt lgkmcnt(0)
    s_cmp_lt_u32 s3, 2
    s_cbranch_scc1 .no10_37
    s_mov_b32 m0, s68
    s_nop 0
    buffer_load_dwordx4 v34, s[52:55], 0 offen lds
.no10_37:
    s_add_u32 m0, s67, 55296
    s_nop 0
    buffer_load_dwordx4 v22, s[52:55], s40 offen lds
    s_add_u32 m0, s67, 59392
    s_nop 0
    buffer_load_dwordx4 v23, s[52:55], s40 offen lds
    s_add_u32 m0, s67, 63488
    s_nop 0
    buffer_load_dwordx4 v24, s[52:55], s40 offen lds
    s_add_u32 m0, s67, 67584
    s_nop 0
    buffer_load_dwordx4 v25, s[52:55], s40 offen lds
    s_add_u32 m0, s67, 71680
    s_nop 0
    buffer_load_dwordx4 v32, s[52:55], 0 offen lds
    s_add_u32 m0, s67, 75776
    s_nop 0
    buffer_load_dwordx4 v33, s[52:55], 0 offen lds
    s_add_u32 m0, s71, 81920
    s_nop 0
    buffer_load_dword v35, s[52:55], 0 offen lds
    s_waitcnt vmcnt(18)
    v_mfma_f32_16x16x32_bf16 v[60:63], a[0:3], v[168:171], 0
    buffer_load_dwordx4 v[196:199], v83, s[48:51], s78 offen offset:3072
    s_lshl_b32 s74, s6, 6
    buffer_load_dword v80, v84, s[48:51], s74 offen
    v_mfma_f32_16x16x32_bf16 v[64:67], a[4:7], v[168:171], 0
    s_mov_b32 s60, s30
    v_mfma_f32_16x16x32_bf16 v[68:71], a[8:11], v[168:171], 0
    s_and_b32 s61, s31, 0xffff
    v_mfma_f32_16x16x32_bf16 v[72:75], a[12:15], v[168:171], 0
    s_mov_b32 s62, 2359296
    v_mfma_f32_16x16x32_bf16 v[76:79], a[16:19], v[168:171], 0
    s_mov_b32 s63, 0x20000
    s_waitcnt vmcnt(19)
    v_mfma_f32_16x16x32_bf16 v[60:63], a[20:23], v[172:175], v[60:63]
    buffer_load_dwordx4 v[116:119], v82, s[48:51], s78 offen offset:1024
    s_lshl_b32 s74, s7, 6
    buffer_load_dword v81, v84, s[48:51], s74 offen
    v_mfma_f32_16x16x32_bf16 v[64:67], a[24:27], v[172:175], v[64:67]
    s_lshr_b32 s72, s6, 3
    v_mfma_f32_16x16x32_bf16 v[68:71], a[28:31], v[172:175], v[68:71]
    s_lshl_b32 s72, s72, 7
    v_mfma_f32_16x16x32_bf16 v[72:75], a[32:35], v[172:175], v[72:75]
    s_and_b32 s73, s6, 3
    v_mfma_f32_16x16x32_bf16 v[76:79], a[36:39], v[172:175], v[76:79]
    s_lshl_b32 s73, s73, 5
    s_waitcnt vmcnt(20)
    v_mfma_f32_16x16x32_bf16 v[60:63], a[40:43], v[176:179], v[60:63]
    buffer_load_dwordx4 v[200:203], v83, s[48:51], s79 offen offset:0
    v_mfma_f32_16x16x32_bf16 v[64:67], a[44:47], v[176:179], v[64:67]
    s_add_u32 s72, s72, s73
    v_mfma_f32_16x16x32_bf16 v[68:71], a[48:51], v[176:179], v[68:71]
    s_bfe_u32 s73, s6, 0x10002
    v_mfma_f32_16x16x32_bf16 v[72:75], a[52:55], v[176:179], v[72:75]
    s_add_u32 s72, s72, s73
    v_mfma_f32_16x16x32_bf16 v[76:79], a[56:59], v[176:179], v[76:79]
    s_mul_i32 s72, s72, 1152
    s_waitcnt vmcnt(20)
    v_mfma_f32_16x16x32_bf16 v[40:43], a[0:3], v[96:99], 0
    buffer_load_dwordx4 v[120:123], v82, s[48:51], s78 offen offset:2048
    v_mfma_f32_16x16x32_bf16 v[44:47], a[4:7], v[96:99], 0
    s_mul_i32 s73, s15, 144
    v_mfma_f32_16x16x32_bf16 v[48:51], a[8:11], v[96:99], 0
    s_add_u32 s72, s72, s73
    v_mfma_f32_16x16x32_bf16 v[52:55], a[12:15], v[96:99], 0
    v_mul_u32_u24 v6, 2304, v3
    v_mfma_f32_16x16x32_bf16 v[56:59], a[16:19], v[96:99], 0
    v_add_u32 v6, s72, v6
    s_waitcnt vmcnt(20)
    v_mfma_f32_16x16x32_bf16 v[60:63], a[60:63], v[180:183], v[60:63]
    buffer_load_dwordx4 v[204:207], v83, s[48:51], s79 offen offset:1024
    v_mfma_f32_16x16x32_bf16 v[64:67], a[64:67], v[180:183], v[64:67]
    v_lshl_add_u32 v95, v2, 3, v6
    v_mfma_f32_16x16x32_bf16 v[68:71], a[68:71], v[180:183], v[68:71]
    v_and_b32 v7, 1, v2
    v_mfma_f32_16x16x32_bf16 v[72:75], a[72:75], v[180:183], v[72:75]
    v_lshl_add_u32 v6, v7, 5, v6
    v_mfma_f32_16x16x32_bf16 v[76:79], a[76:79], v[180:183], v[76:79]
    v_lshrrev_b32 v7, 1, v2
    s_waitcnt vmcnt(20)
    v_mfma_f32_16x16x32_bf16 v[40:43], a[20:23], v[100:103], v[40:43]
    buffer_load_dwordx4 v[124:127], v82, s[48:51], s78 offen offset:3072
    v_mfma_f32_16x16x32_bf16 v[44:47], a[24:27], v[100:103], v[44:47]
    v_lshl_add_u32 v85, v7, 4, v6
    v_mfma_f32_16x16x32_bf16 v[48:51], a[28:31], v[100:103], v[48:51]
    s_mul_i32 s72, s3, 2560
    v_mfma_f32_16x16x32_bf16 v[52:55], a[32:35], v[100:103], v[52:55]
    s_add_u32 s72, s72, 138240
    v_mfma_f32_16x16x32_bf16 v[56:59], a[36:39], v[100:103], v[56:59]
    v_lshlrev_b32 v6, 3, v1
    s_waitcnt vmcnt(20)
    v_mfma_f32_16x16x32_bf16 v[60:63], a[80:83], v[184:187], v[60:63]
    buffer_load_dwordx4 v[208:211], v83, s[48:51], s79 offen offset:2048
    v_mfma_f32_16x16x32_bf16 v[64:67], a[84:87], v[184:187], v[64:67]
    v_add_u32 v86, s72, v6
    v_mfma_f32_16x16x32_bf16 v[68:71], a[88:91], v[184:187], v[68:71]
    s_xor_b32 s72, s3, 2
    v_mfma_f32_16x16x32_bf16 v[72:75], a[92:95], v[184:187], v[72:75]
    s_mul_i32 s72, s72, 2560
    v_mfma_f32_16x16x32_bf16 v[76:79], a[96:99], v[184:187], v[76:79]
    s_add_u32 s72, s72, 138240
    s_waitcnt vmcnt(20)
    v_mfma_f32_16x16x32_bf16 v[40:43], a[40:43], v[104:107], v[40:43]
    buffer_load_dwordx4 v[128:131], v82, s[48:51], s79 offen offset:0
    v_mfma_f32_16x16x32_bf16 v[44:47], a[44:47], v[104:107], v[44:47]
    v_add_u32 v87, s72, v6
    v_mfma_f32_16x16x32_bf16 v[48:51], a[48:51], v[104:107], v[48:51]
    v_mfma_f32_16x16x32_bf16 v[52:55], a[52:55], v[104:107], v[52:55]
    v_mfma_f32_16x16x32_bf16 v[56:59], a[56:59], v[104:107], v[56:59]
    s_waitcnt vmcnt(20)
    v_mfma_f32_16x16x32_bf16 v[60:63], a[100:103], v[188:191], v[60:63]
    buffer_load_dwordx4 v[212:215], v83, s[48:51], s79 offen offset:3072
    v_mfma_f32_16x16x32_bf16 v[64:67], a[104:107], v[188:191], v[64:67]
    v_mfma_f32_16x16x32_bf16 v[68:71], a[108:111], v[188:191], v[68:71]
    v_mfma_f32_16x16x32_bf16 v[72:75], a[112:115], v[188:191], v[72:75]
    v_mfma_f32_16x16x32_bf16 v[76:79], a[116:119], v[188:191], v[76:79]
    s_waitcnt vmcnt(20)
    v_mfma_f32_16x16x32_bf16 v[40:43], a[60:63], v[108:111], v[40:43]
    buffer_load_dwordx4 v[132:135], v82, s[48:51], s79 offen offset:1024
    v_mfma_f32_16x16x32_bf16 v[44:47], a[64:67], v[108:111], v[44:47]
    v_mfma_f32_16x16x32_bf16 v[48:51], a[68:71], v[108:111], v[48:51]
    v_mfma_f32_16x16x32_bf16 v[52:55], a[72:75], v[108:111], v[52:55]
    v_mfma_f32_16x16x32_bf16 v[56:59], a[76:79], v[108:111], v[56:59]
    s_waitcnt vmcnt(20)
    v_mfma_f32_16x16x32_bf16 v[60:63], a[120:123], v[192:195], v[60:63]
    buffer_load_dwordx4 v[216:219], v83, s[48:51], s80 offen offset:0
    s_waitcnt vmcnt(9)
    v_mfma_f32_16x16x32_bf16 v[64:67], a[124:127], v[192:195], v[64:67]
    s_mov_b32 s74, 1069066811
    s_cmp_eq_u32 s8, 0
    s_cselect_b64 vcc, -1, 0
    v_mfma_f32_16x16x32_bf16 v[68:71], a[128:131], v[192:195], v[68:71]
    v_cvt_pk_bf16_f32 v80, 0, v80
    v_cvt_pk_bf16_f32 v81, 0, v81
    v_mfma_f32_16x16x32_bf16 v[72:75], a[132:135], v[192:195], v[72:75]
    v_mul_f32 v80, s74, v80
    v_mfma_f32_16x16x32_bf16 v[76:79], a[136:139], v[192:195], v[76:79]
    v_mul_f32 v81, s74, v81
    s_waitcnt vmcnt(20)
    v_mfma_f32_16x16x32_bf16 v[40:43], a[80:83], v[112:115], v[40:43]
    buffer_load_dwordx4 v[136:139], v82, s[48:51], s79 offen offset:2048
    v_exp_f32 v80, -v80
    v_mfma_f32_16x16x32_bf16 v[44:47], a[84:87], v[112:115], v[44:47]
    v_exp_f32 v81, -v81
    v_add_f32 v80, 1.0, v80
    v_mfma_f32_16x16x32_bf16 v[48:51], a[88:91], v[112:115], v[48:51]
    v_add_f32 v81, 1.0, v81
    v_rcp_f32 v80, v80
    v_mfma_f32_16x16x32_bf16 v[52:55], a[92:95], v[112:115], v[52:55]
    v_rcp_f32 v81, v81
    v_mfma_f32_16x16x32_bf16 v[56:59], a[96:99], v[112:115], v[56:59]
    v_cvt_pk_bf16_f32 v80, 0, v80
    s_waitcnt vmcnt(13)
    v_mfma_f32_16x16x32_bf16 v[60:63], a[140:143], v[196:199], v[60:63]
    buffer_load_dwordx4 v[220:223], v83, s[48:51], s80 offen offset:1024
    v_cvt_pk_bf16_f32 v81, 0, v81
    v_mfma_f32_16x16x32_bf16 v[64:67], a[144:147], v[196:199], v[64:67]
    v_sub_f32 v8, 1.0, v80
    v_sub_f32 v9, 1.0, v81
    v_mfma_f32_16x16x32_bf16 v[68:71], a[148:151], v[196:199], v[68:71]
    v_cvt_pk_bf16_f32 v8, 0, v8
    v_cvt_pk_bf16_f32 v9, 0, v9
    v_mfma_f32_16x16x32_bf16 v[72:75], a[152:155], v[196:199], v[72:75]
    v_cndmask_b32 v90, v8, v80, vcc
    v_mfma_f32_16x16x32_bf16 v[76:79], a[156:159], v[196:199], v[76:79]
    v_cndmask_b32 v91, v9, v81, vcc
    s_waitcnt vmcnt(12)
    v_mfma_f32_16x16x32_bf16 v[40:43], a[100:103], v[116:119], v[40:43]
    buffer_load_dwordx4 v[140:143], v82, s[48:51], s79 offen offset:3072
    v_mfma_f32_16x16x32_bf16 v[44:47], a[104:107], v[116:119], v[44:47]
    v_mfma_f32_16x16x32_bf16 v[48:51], a[108:111], v[116:119], v[48:51]
    v_mfma_f32_16x16x32_bf16 v[52:55], a[112:115], v[116:119], v[52:55]
    v_mfma_f32_16x16x32_bf16 v[56:59], a[116:119], v[116:119], v[56:59]
    s_branch .Lsk5
.Lpad5:
    s_branch .Lpret
.Lsk5:
    s_waitcnt vmcnt(11)
    s_waitcnt vmcnt(16)
    s_barrier
    v_mfma_f32_16x16x32_bf16 v[60:63], a[160:163], v[200:203], v[60:63]
    buffer_load_dwordx4 v[224:227], v83, s[48:51], s80 offen offset:2048
    ds_read_b64_tr_b16 a[0:1], v94 offset:13824
    v_mfma_f32_16x16x32_bf16 v[64:67], a[164:167], v[200:203], v[64:67]
    ds_read_b64_tr_b16 a[2:3], v94 offset:13968
    v_mfma_f32_16x16x32_bf16 v[68:71], a[168:171], v[200:203], v[68:71]
    ds_read_b64_tr_b16 a[4:5], v94 offset:13856
    v_mfma_f32_16x16x32_bf16 v[72:75], a[172:175], v[200:203], v[72:75]
    ds_read_b64_tr_b16 a[6:7], v94 offset:14000
    v_mfma_f32_16x16x32_bf16 v[76:79], a[176:179], v[200:203], v[76:79]
    ds_read_b64_tr_b16 a[8:9], v94 offset:13888
    s_waitcnt vmcnt(11)
    v_mfma_f32_16x16x32_bf16 v[40:43], a[120:123], v[120:123], v[40:43]
    buffer_load_dwordx4 v[144:147], v82, s[48:51], s80 offen offset:0
    ds_read_b64_tr_b16 a[10:11], v94 offset:14032
    v_mfma_f32_16x16x32_bf16 v[44:47], a[124:127], v[120:123], v[44:47]
    ds_read_b64_tr_b16 a[12:13], v94 offset:13920
    v_mfma_f32_16x16x32_bf16 v[48:51], a[128:131], v[120:123], v[48:51]
    ds_read_b64_tr_b16 a[14:15], v94 offset:14064
    v_mfma_f32_16x16x32_bf16 v[52:55], a[132:135], v[120:123], v[52:55]
    ds_read_b64_tr_b16 a[16:17], v94 offset:13952
    v_mfma_f32_16x16x32_bf16 v[56:59], a[136:139], v[120:123], v[56:59]
    ds_read_b64_tr_b16 a[18:19], v94 offset:14096
    s_waitcnt vmcnt(11)
    v_mfma_f32_16x16x32_bf16 v[60:63], a[180:183], v[204:207], v[60:63]
    buffer_load_dwordx4 v[228:231], v83, s[48:51], s80 offen offset:3072
    ds_read_b64_tr_b16 a[20:21], v94 offset:18432
    v_mfma_f32_16x16x32_bf16 v[64:67], a[184:187], v[204:207], v[64:67]
    ds_read_b64_tr_b16 a[22:23], v94 offset:18576
    v_mfma_f32_16x16x32_bf16 v[68:71], a[188:191], v[204:207], v[68:71]
    ds_read_b64_tr_b16 a[24:25], v94 offset:18464
    v_mfma_f32_16x16x32_bf16 v[72:75], a[192:195], v[204:207], v[72:75]
    ds_read_b64_tr_b16 a[26:27], v94 offset:18608
    v_mfma_f32_16x16x32_bf16 v[76:79], a[196:199], v[204:207], v[76:79]
    ds_read_b64_tr_b16 a[28:29], v94 offset:18496
    s_waitcnt vmcnt(11)
    v_mfma_f32_16x16x32_bf16 v[40:43], a[140:143], v[124:127], v[40:43]
    buffer_load_dwordx4 v[148:151], v82, s[48:51], s80 offen offset:1024
    ds_read_b64_tr_b16 a[30:31], v94 offset:18640
    v_mfma_f32_16x16x32_bf16 v[44:47], a[144:147], v[124:127], v[44:47]
    ds_read_b64_tr_b16 a[32:33], v94 offset:18528
    v_mfma_f32_16x16x32_bf16 v[48:51], a[148:151], v[124:127], v[48:51]
    ds_read_b64_tr_b16 a[34:35], v94 offset:18672
    v_mfma_f32_16x16x32_bf16 v[52:55], a[152:155], v[124:127], v[52:55]
    ds_read_b64_tr_b16 a[36:37], v94 offset:18560
    v_mfma_f32_16x16x32_bf16 v[56:59], a[156:159], v[124:127], v[56:59]
    ds_read_b64_tr_b16 a[38:39], v94 offset:18704
    s_waitcnt vmcnt(11)
    v_mfma_f32_16x16x32_bf16 v[60:63], a[200:203], v[208:211], v[60:63]
    buffer_load_dwordx4 v[232:235], v83, s[48:51], s81 offen offset:0
    ds_read_b64_tr_b16 a[40:41], v94 offset:23040
    v_mfma_f32_16x16x32_bf16 v[64:67], a[204:207], v[208:211], v[64:67]
    ds_read_b64_tr_b16 a[42:43], v94 offset:23184
    v_mfma_f32_16x16x32_bf16 v[68:71], a[208:211], v[208:211], v[68:71]
    ds_read_b64_tr_b16 a[44:45], v94 offset:23072
    v_mfma_f32_16x16x32_bf16 v[72:75], a[212:215], v[208:211], v[72:75]
    ds_read_b64_tr_b16 a[46:47], v94 offset:23216
    v_mfma_f32_16x16x32_bf16 v[76:79], a[216:219], v[208:211], v[76:79]
    ds_read_b64_tr_b16 a[48:49], v94 offset:23104
    s_waitcnt vmcnt(11)
    v_mfma_f32_16x16x32_bf16 v[40:43], a[160:163], v[128:131], v[40:43]
    buffer_load_dwordx4 v[152:155], v82, s[48:51], s80 offen offset:2048
    ds_read_b64_tr_b16 a[50:51], v94 offset:23248
    v_mfma_f32_16x16x32_bf16 v[44:47], a[164:167], v[128:131], v[44:47]
    ds_read_b64_tr_b16 a[52:53], v94 offset:23136
    v_mfma_f32_16x16x32_bf16 v[48:51], a[168:171], v[128:131], v[48:51]
    ds_read_b64_tr_b16 a[54:55], v94 offset:23280
    v_mfma_f32_16x16x32_bf16 v[52:55], a[172:175], v[128:131], v[52:55]
    ds_read_b64_tr_b16 a[56:57], v94 offset:23168
    v_mfma_f32_16x16x32_bf16 v[56:59], a[176:179], v[128:131], v[56:59]
    ds_read_b64_tr_b16 a[58:59], v94 offset:23312
    s_waitcnt vmcnt(11)
    v_mfma_f32_16x16x32_bf16 v[60:63], a[220:223], v[212:215], v[60:63]
    buffer_load_dwordx4 v[236:239], v83, s[48:51], s81 offen offset:1024
    ds_read_b64_tr_b16 a[60:61], v94 offset:27648
    v_mfma_f32_16x16x32_bf16 v[64:67], a[224:227], v[212:215], v[64:67]
    ds_read_b64_tr_b16 a[62:63], v94 offset:27792
    v_mfma_f32_16x16x32_bf16 v[68:71], a[228:231], v[212:215], v[68:71]
    ds_read_b64_tr_b16 a[64:65], v94 offset:27680
    v_mfma_f32_16x16x32_bf16 v[72:75], a[232:235], v[212:215], v[72:75]
    ds_read_b64_tr_b16 a[66:67], v94 offset:27824
    v_mfma_f32_16x16x32_bf16 v[76:79], a[236:239], v[212:215], v[76:79]
    ds_read_b64_tr_b16 a[68:69], v94 offset:27712
    s_waitcnt vmcnt(11)
    v_mfma_f32_16x16x32_bf16 v[40:43], a[180:183], v[132:135], v[40:43]
    buffer_load_dwordx4 v[156:159], v82, s[48:51], s80 offen offset:3072
    ds_read_b64_tr_b16 a[70:71], v94 offset:27856
    v_mfma_f32_16x16x32_bf16 v[44:47], a[184:187], v[132:135], v[44:47]
    ds_read_b64_tr_b16 a[72:73], v94 offset:27744
    v_mfma_f32_16x16x32_bf16 v[48:51], a[188:191], v[132:135], v[48:51]
    ds_read_b64_tr_b16 a[74:75], v94 offset:27888
    v_mfma_f32_16x16x32_bf16 v[52:55], a[192:195], v[132:135], v[52:55]
    ds_read_b64_tr_b16 a[76:77], v94 offset:27776
    v_mfma_f32_16x16x32_bf16 v[56:59], a[196:199], v[132:135], v[56:59]
    ds_read_b64_tr_b16 a[78:79], v94 offset:27920
    s_waitcnt vmcnt(11) lgkmcnt(15)
    v_mfma_f32_16x16x32_bf16 v[60:63], a[0:3], v[216:219], v[60:63]
    buffer_load_dwordx4 v[160:163], v82, s[48:51], s81 offen offset:0
    ds_read_b64_tr_b16 a[80:81], v94 offset:32256
    v_mfma_f32_16x16x32_bf16 v[64:67], a[4:7], v[216:219], v[64:67]
    ds_read_b64_tr_b16 a[82:83], v94 offset:32400
    v_mfma_f32_16x16x32_bf16 v[68:71], a[8:11], v[216:219], v[68:71]
    ds_read_b64_tr_b16 a[84:85], v94 offset:32288
    v_mfma_f32_16x16x32_bf16 v[72:75], a[12:15], v[216:219], v[72:75]
    ds_read_b64_tr_b16 a[86:87], v94 offset:32432
    v_mfma_f32_16x16x32_bf16 v[76:79], a[16:19], v[216:219], v[76:79]
    ds_read_b64_tr_b16 a[88:89], v94 offset:32320
    s_waitcnt vmcnt(11)
    v_mfma_f32_16x16x32_bf16 v[40:43], a[200:203], v[136:139], v[40:43]
    buffer_load_dwordx4 v[164:167], v82, s[48:51], s81 offen offset:1024
    ds_read_b64_tr_b16 a[90:91], v94 offset:32464
    v_mfma_f32_16x16x32_bf16 v[44:47], a[204:207], v[136:139], v[44:47]
    ds_read_b64_tr_b16 a[92:93], v94 offset:32352
    v_mfma_f32_16x16x32_bf16 v[48:51], a[208:211], v[136:139], v[48:51]
    ds_read_b64_tr_b16 a[94:95], v94 offset:32496
    v_mfma_f32_16x16x32_bf16 v[52:55], a[212:215], v[136:139], v[52:55]
    ds_read_b64_tr_b16 a[96:97], v94 offset:32384
    v_mfma_f32_16x16x32_bf16 v[56:59], a[216:219], v[136:139], v[56:59]
    ds_read_b64_tr_b16 a[98:99], v94 offset:32528
    s_waitcnt vmcnt(11) lgkmcnt(15)
    v_mfma_f32_16x16x32_bf16 v[60:63], a[20:23], v[220:223], v[60:63]
    ds_read_b64_tr_b16 a[100:101], v94 offset:36864
    v_mfma_f32_16x16x32_bf16 v[64:67], a[24:27], v[220:223], v[64:67]
    ds_read_b64_tr_b16 a[102:103], v94 offset:37008
    v_mfma_f32_16x16x32_bf16 v[68:71], a[28:31], v[220:223], v[68:71]
    ds_read_b64_tr_b16 a[104:105], v94 offset:36896
    v_mfma_f32_16x16x32_bf16 v[72:75], a[32:35], v[220:223], v[72:75]
    ds_read_b64_tr_b16 a[106:107], v94 offset:37040
    v_mfma_f32_16x16x32_bf16 v[76:79], a[36:39], v[220:223], v[76:79]
    ds_read_b64_tr_b16 a[108:109], v94 offset:36928
    s_waitcnt vmcnt(10)
    v_mfma_f32_16x16x32_bf16 v[40:43], a[220:223], v[140:143], v[40:43]
    ds_read_b64_tr_b16 a[110:111], v94 offset:37072
    v_mfma_f32_16x16x32_bf16 v[44:47], a[224:227], v[140:143], v[44:47]
    ds_read_b64_tr_b16 a[112:113], v94 offset:36960
    v_mfma_f32_16x16x32_bf16 v[48:51], a[228:231], v[140:143], v[48:51]
    ds_read_b64_tr_b16 a[114:115], v94 offset:37104
    v_mfma_f32_16x16x32_bf16 v[52:55], a[232:235], v[140:143], v[52:55]
    ds_read_b64_tr_b16 a[116:117], v94 offset:36992
    v_mfma_f32_16x16x32_bf16 v[56:59], a[236:239], v[140:143], v[56:59]
    ds_read_b64_tr_b16 a[118:119], v94 offset:37136
    s_waitcnt vmcnt(9) lgkmcnt(15)
    v_mfma_f32_16x16x32_bf16 v[60:63], a[40:43], v[224:227], v[60:63]
    v_mfma_f32_16x16x32_bf16 v[64:67], a[44:47], v[224:227], v[64:67]
    v_mfma_f32_16x16x32_bf16 v[68:71], a[48:51], v[224:227], v[68:71]
    v_mfma_f32_16x16x32_bf16 v[72:75], a[52:55], v[224:227], v[72:75]
    v_mfma_f32_16x16x32_bf16 v[76:79], a[56:59], v[224:227], v[76:79]
    s_waitcnt vmcnt(8)
    v_mfma_f32_16x16x32_bf16 v[40:43], a[0:3], v[144:147], v[40:43]
    v_mfma_f32_16x16x32_bf16 v[44:47], a[4:7], v[144:147], v[44:47]
    v_mfma_f32_16x16x32_bf16 v[48:51], a[8:11], v[144:147], v[48:51]
    v_mfma_f32_16x16x32_bf16 v[52:55], a[12:15], v[144:147], v[52:55]
    v_mfma_f32_16x16x32_bf16 v[56:59], a[16:19], v[144:147], v[56:59]
    s_waitcnt vmcnt(7) lgkmcnt(15)
    v_mfma_f32_16x16x32_bf16 v[60:63], a[60:63], v[228:231], v[60:63]
    v_mfma_f32_16x16x32_bf16 v[64:67], a[64:67], v[228:231], v[64:67]
    v_mfma_f32_16x16x32_bf16 v[68:71], a[68:71], v[228:231], v[68:71]
    v_mfma_f32_16x16x32_bf16 v[72:75], a[72:75], v[228:231], v[72:75]
    v_mfma_f32_16x16x32_bf16 v[76:79], a[76:79], v[228:231], v[76:79]
    s_waitcnt vmcnt(6)
    v_mfma_f32_16x16x32_bf16 v[40:43], a[20:23], v[148:151], v[40:43]
    v_mfma_f32_16x16x32_bf16 v[44:47], a[24:27], v[148:151], v[44:47]
    v_mfma_f32_16x16x32_bf16 v[48:51], a[28:31], v[148:151], v[48:51]
    v_mfma_f32_16x16x32_bf16 v[52:55], a[32:35], v[148:151], v[52:55]
    v_mfma_f32_16x16x32_bf16 v[56:59], a[36:39], v[148:151], v[56:59]
    s_waitcnt vmcnt(5) lgkmcnt(10)
    v_mfma_f32_16x16x32_bf16 v[60:63], a[80:83], v[232:235], v[60:63]
    v_mfma_f32_16x16x32_bf16 v[64:67], a[84:87], v[232:235], v[64:67]
    v_mfma_f32_16x16x32_bf16 v[68:71], a[88:91], v[232:235], v[68:71]
    v_mfma_f32_16x16x32_bf16 v[72:75], a[92:95], v[232:235], v[72:75]
    v_mfma_f32_16x16x32_bf16 v[76:79], a[96:99], v[232:235], v[76:79]
    s_waitcnt vmcnt(4)
    v_mfma_f32_16x16x32_bf16 v[40:43], a[40:43], v[152:155], v[40:43]
    v_mfma_f32_16x16x32_bf16 v[44:47], a[44:47], v[152:155], v[44:47]
    v_mfma_f32_16x16x32_bf16 v[48:51], a[48:51], v[152:155], v[48:51]
    v_mfma_f32_16x16x32_bf16 v[52:55], a[52:55], v[152:155], v[52:55]
    v_mfma_f32_16x16x32_bf16 v[56:59], a[56:59], v[152:155], v[56:59]
    s_waitcnt vmcnt(3) lgkmcnt(0)
    v_mfma_f32_16x16x32_bf16 v[60:63], a[100:103], v[236:239], v[60:63]
    v_mfma_f32_16x16x32_bf16 v[64:67], a[104:107], v[236:239], v[64:67]
    v_mfma_f32_16x16x32_bf16 v[68:71], a[108:111], v[236:239], v[68:71]
    v_mfma_f32_16x16x32_bf16 v[72:75], a[112:115], v[236:239], v[72:75]
    v_mfma_f32_16x16x32_bf16 v[76:79], a[116:119], v[236:239], v[76:79]
    s_waitcnt vmcnt(2)
    v_mfma_f32_16x16x32_bf16 v[40:43], a[60:63], v[156:159], v[40:43]
    s_nop 1
    v_cvt_pk_bf16_f32 v60, 0, v60
    v_cvt_pk_bf16_f32 v64, 0, v64
    v_cvt_pk_bf16_f32 v68, 0, v68
    v_mfma_f32_16x16x32_bf16 v[44:47], a[64:67], v[156:159], v[44:47]
    v_cvt_pk_bf16_f32 v72, 0, v72
    v_cvt_pk_bf16_f32 v76, 0, v76
    v_cvt_pk_bf16_f32 v61, 0, v61
    v_mfma_f32_16x16x32_bf16 v[48:51], a[68:71], v[156:159], v[48:51]
    v_cvt_pk_bf16_f32 v65, 0, v65
    v_cvt_pk_bf16_f32 v69, 0, v69
    v_cvt_pk_bf16_f32 v73, 0, v73
    v_mfma_f32_16x16x32_bf16 v[52:55], a[72:75], v[156:159], v[52:55]
    v_cvt_pk_bf16_f32 v77, 0, v77
    v_cvt_pk_bf16_f32 v62, 0, v62
    v_cvt_pk_bf16_f32 v66, 0, v66
    v_mfma_f32_16x16x32_bf16 v[56:59], a[76:79], v[156:159], v[56:59]
    v_cvt_pk_bf16_f32 v70, 0, v70
    v_cvt_pk_bf16_f32 v74, 0, v74
    v_cvt_pk_bf16_f32 v78, 0, v78
    s_waitcnt vmcnt(1)
    v_mfma_f32_16x16x32_bf16 v[40:43], a[80:83], v[160:163], v[40:43]
    v_cvt_pk_bf16_f32 v63, 0, v63
    v_cvt_pk_bf16_f32 v67, 0, v67
    v_cvt_pk_bf16_f32 v71, 0, v71
    v_mfma_f32_16x16x32_bf16 v[44:47], a[84:87], v[160:163], v[44:47]
    v_cvt_pk_bf16_f32 v75, 0, v75
    v_cvt_pk_bf16_f32 v79, 0, v79
    v_pk_mul_f32 v[60:61], v[60:61], v[90:91] op_sel:[0,1] op_sel_hi:[1,1]
    v_mfma_f32_16x16x32_bf16 v[48:51], a[88:91], v[160:163], v[48:51]
    v_pk_mul_f32 v[64:65], v[64:65], v[90:91] op_sel:[0,1] op_sel_hi:[1,1]
    v_pk_mul_f32 v[68:69], v[68:69], v[90:91] op_sel:[0,1] op_sel_hi:[1,1]
    v_pk_mul_f32 v[72:73], v[72:73], v[90:91] op_sel:[0,1] op_sel_hi:[1,1]
    v_mfma_f32_16x16x32_bf16 v[52:55], a[92:95], v[160:163], v[52:55]
    v_pk_mul_f32 v[76:77], v[76:77], v[90:91] op_sel:[0,1] op_sel_hi:[1,1]
    v_pk_mul_f32 v[62:63], v[62:63], v[90:91] op_sel:[0,1] op_sel_hi:[1,1]
    v_pk_mul_f32 v[66:67], v[66:67], v[90:91] op_sel:[0,1] op_sel_hi:[1,1]
    v_mfma_f32_16x16x32_bf16 v[56:59], a[96:99], v[160:163], v[56:59]
    v_pk_mul_f32 v[70:71], v[70:71], v[90:91] op_sel:[0,1] op_sel_hi:[1,1]
    v_pk_mul_f32 v[74:75], v[74:75], v[90:91] op_sel:[0,1] op_sel_hi:[1,1]
    v_pk_mul_f32 v[78:79], v[78:79], v[90:91] op_sel:[0,1] op_sel_hi:[1,1]
    s_waitcnt vmcnt(0)
    v_mfma_f32_16x16x32_bf16 v[40:43], a[100:103], v[164:167], v[40:43]
    v_cvt_pk_bf16_f32 v240, v60, v61
    v_cvt_pk_bf16_f32 v242, v64, v65
    v_cvt_pk_bf16_f32 v244, v68, v69
    v_mfma_f32_16x16x32_bf16 v[44:47], a[104:107], v[164:167], v[44:47]
    v_cvt_pk_bf16_f32 v246, v72, v73
    v_cvt_pk_bf16_f32 v248, v76, v77
    v_cvt_pk_bf16_f32 v241, v62, v63
    v_mfma_f32_16x16x32_bf16 v[48:51], a[108:111], v[164:167], v[48:51]
    v_cvt_pk_bf16_f32 v243, v66, v67
    v_cvt_pk_bf16_f32 v245, v70, v71
    v_cvt_pk_bf16_f32 v247, v74, v75
    v_mfma_f32_16x16x32_bf16 v[52:55], a[112:115], v[164:167], v[52:55]
    v_cvt_pk_bf16_f32 v249, v78, v79
    ds_write_b64 v86, v[240:241] offset:0
    ds_write_b64 v86, v[242:243] offset:512
    v_mfma_f32_16x16x32_bf16 v[56:59], a[116:119], v[164:167], v[56:59]
    ds_write_b64 v86, v[244:245] offset:1024
    ds_write_b64 v86, v[246:247] offset:1536
    ds_write_b64 v86, v[248:249] offset:2048
    v_cvt_pk_bf16_f32 v40, 0, v40
    v_cvt_pk_bf16_f32 v44, 0, v44
    v_cvt_pk_bf16_f32 v48, 0, v48
    v_cvt_pk_bf16_f32 v52, 0, v52
    s_nop 0
    v_cvt_pk_bf16_f32 v56, 0, v56
    v_cvt_pk_bf16_f32 v41, 0, v41
    v_cvt_pk_bf16_f32 v45, 0, v45
    v_cvt_pk_bf16_f32 v49, 0, v49
    v_cvt_pk_bf16_f32 v53, 0, v53
    v_cvt_pk_bf16_f32 v57, 0, v57
    v_cvt_pk_bf16_f32 v42, 0, v42
    v_cvt_pk_bf16_f32 v46, 0, v46
    v_cvt_pk_bf16_f32 v50, 0, v50
    v_cvt_pk_bf16_f32 v54, 0, v54
    v_cvt_pk_bf16_f32 v58, 0, v58
    v_cvt_pk_bf16_f32 v43, 0, v43
    v_cvt_pk_bf16_f32 v47, 0, v47
    v_cvt_pk_bf16_f32 v51, 0, v51
    v_cvt_pk_bf16_f32 v55, 0, v55
    v_cvt_pk_bf16_f32 v59, 0, v59
    s_waitcnt lgkmcnt(0)
    s_barrier
    ds_read_b64 v[112:113], v87 offset:0
    ds_read_b64 v[114:115], v87 offset:512
    ds_read_b64 v[116:117], v87 offset:1024
    ds_read_b64 v[118:119], v87 offset:1536
    ds_read_b64 v[120:121], v87 offset:2048
    v_pk_mul_f32 v[40:41], v[40:41], v[90:91] op_sel_hi:[1,0]
    v_pk_mul_f32 v[44:45], v[44:45], v[90:91] op_sel_hi:[1,0]
    v_pk_mul_f32 v[48:49], v[48:49], v[90:91] op_sel_hi:[1,0]
    v_pk_mul_f32 v[52:53], v[52:53], v[90:91] op_sel_hi:[1,0]
    v_pk_mul_f32 v[56:57], v[56:57], v[90:91] op_sel_hi:[1,0]
    v_pk_mul_f32 v[42:43], v[42:43], v[90:91] op_sel_hi:[1,0]
    v_pk_mul_f32 v[46:47], v[46:47], v[90:91] op_sel_hi:[1,0]
    v_pk_mul_f32 v[50:51], v[50:51], v[90:91] op_sel_hi:[1,0]
    v_pk_mul_f32 v[54:55], v[54:55], v[90:91] op_sel_hi:[1,0]
    v_pk_mul_f32 v[58:59], v[58:59], v[90:91] op_sel_hi:[1,0]
    v_cvt_pk_bf16_f32 v40, 0, v40
    v_cvt_pk_bf16_f32 v44, 0, v44
    v_cvt_pk_bf16_f32 v48, 0, v48
    v_cvt_pk_bf16_f32 v52, 0, v52
    v_cvt_pk_bf16_f32 v56, 0, v56
    v_cvt_pk_bf16_f32 v41, 0, v41
    v_cvt_pk_bf16_f32 v45, 0, v45
    v_cvt_pk_bf16_f32 v49, 0, v49
    v_cvt_pk_bf16_f32 v53, 0, v53
    v_cvt_pk_bf16_f32 v57, 0, v57
    v_cvt_pk_bf16_f32 v42, 0, v42
    v_cvt_pk_bf16_f32 v46, 0, v46
    v_cvt_pk_bf16_f32 v50, 0, v50
    v_cvt_pk_bf16_f32 v54, 0, v54
    v_cvt_pk_bf16_f32 v58, 0, v58
    v_cvt_pk_bf16_f32 v43, 0, v43
    v_cvt_pk_bf16_f32 v47, 0, v47
    v_cvt_pk_bf16_f32 v51, 0, v51
    v_cvt_pk_bf16_f32 v55, 0, v55
    v_cvt_pk_bf16_f32 v59, 0, v59
    s_waitcnt lgkmcnt(0)
    v_lshlrev_b32 v60, 16, v112
    v_and_b32 v61, 0xffff0000, v112
    v_lshlrev_b32 v62, 16, v113
    v_and_b32 v63, 0xffff0000, v113
    v_lshlrev_b32 v64, 16, v114
    v_and_b32 v65, 0xffff0000, v114
    v_lshlrev_b32 v66, 16, v115
    v_and_b32 v67, 0xffff0000, v115
    v_lshlrev_b32 v68, 16, v116
    v_and_b32 v69, 0xffff0000, v116
    v_lshlrev_b32 v70, 16, v117
    v_and_b32 v71, 0xffff0000, v117
    v_lshlrev_b32 v72, 16, v118
    v_and_b32 v73, 0xffff0000, v118
    v_lshlrev_b32 v74, 16, v119
    v_and_b32 v75, 0xffff0000, v119
    v_lshlrev_b32 v76, 16, v120
    v_and_b32 v77, 0xffff0000, v120
    v_lshlrev_b32 v78, 16, v121
    v_and_b32 v79, 0xffff0000, v121
    v_pk_add_f32 v[40:41], v[40:41], v[60:61]
    v_pk_add_f32 v[42:43], v[42:43], v[62:63]
    v_pk_add_f32 v[44:45], v[44:45], v[64:65]
    v_pk_add_f32 v[46:47], v[46:47], v[66:67]
    v_pk_add_f32 v[48:49], v[48:49], v[68:69]
    v_pk_add_f32 v[50:51], v[50:51], v[70:71]
    v_pk_add_f32 v[52:53], v[52:53], v[72:73]
    v_pk_add_f32 v[54:55], v[54:55], v[74:75]
    v_pk_add_f32 v[56:57], v[56:57], v[76:77]
    v_pk_add_f32 v[58:59], v[58:59], v[78:79]
    v_cvt_pk_bf16_f32 v128, v40, v41
    v_cvt_pk_bf16_f32 v129, v42, v43
    v_cvt_pk_bf16_f32 v130, v44, v45
    v_cvt_pk_bf16_f32 v131, v46, v47
    v_cvt_pk_bf16_f32 v132, v48, v49
    v_cvt_pk_bf16_f32 v133, v50, v51
    v_cvt_pk_bf16_f32 v134, v52, v53
    v_cvt_pk_bf16_f32 v135, v54, v55
    v_cvt_pk_bf16_f32 v136, v56, v57
    v_cvt_pk_bf16_f32 v137, v58, v59
    v_permlane16_swap_b32 v128, v130
    v_permlane16_swap_b32 v129, v131
    v_permlane16_swap_b32 v132, v134
    v_permlane16_swap_b32 v133, v135
    buffer_store_dwordx4 v[128:131], v85, s[60:63], 0 offen
    buffer_store_dwordx4 v[132:135], v85, s[60:63], 0 offen offset:64
    s_mov_b32 s78, -1
    s_mov_b32 s79, 0
    s_mov_b64 exec, s[78:79]
    buffer_store_dwordx2 v[136:137], v95, s[60:63], 0 offen offset:128
    s_mov_b64 exec, -1
.Lend:
    s_endpgm
.Lfb:
    s_nop 4
    s_mul_i32 s75, s15, 144
    s_mov_b32 s52, s20
    s_and_b32 s53, s21, 0xffff
    s_mov_b32 s54, 663552
    s_mov_b32 s56, s26
    s_and_b32 s57, s27, 0xffff
    s_mov_b32 s58, 663552
    s_mov_b32 s36, 165888
    s_mov_b32 s37, 248832
    s_mov_b32 s39, 331776
    s_mov_b32 s40, 497664
    v_mul_u32_u24 v6, 1821, v0
    v_lshrrev_b32 v6, 14, v6
    v_mul_u32_u24 v7, 9, v6
    v_sub_u32 v7, v0, v7
    v_lshl_add_u32 v7, v7, 4, s75
    v_bfe_u32 v8, v6, 1, 2
    v_and_b32 v9, 1, v6
    v_lshl_or_b32 v8, v9, 2, v8
    v_lshrrev_b32 v9, 4, v6
    v_mul_u32_u24 v220, 18, v9
    v_and_b32 v9, 1, v9
    v_lshl_add_u32 v220, v9, 1, v220
    v_and_b32 v9, 8, v6
    v_add3_u32 v220, v220, v9, v8
    v_mul_u32_u24 v220, 1152, v220
    v_add_u32 v22, v220, v7
    v_add_u32 v222, 256, v0
    v_mul_u32_u24 v6, 1821, v222
    v_lshrrev_b32 v6, 14, v6
    v_mul_u32_u24 v7, 9, v6
    v_sub_u32 v7, v222, v7
    v_lshl_add_u32 v7, v7, 4, s75
    v_bfe_u32 v8, v6, 1, 2
    v_and_b32 v9, 1, v6
    v_lshl_or_b32 v8, v9, 2, v8
    v_lshrrev_b32 v9, 4, v6
    v_mul_u32_u24 v220, 18, v9
    v_and_b32 v9, 1, v9
    v_lshl_add_u32 v220, v9, 1, v220
    v_and_b32 v9, 8, v6
    v_add3_u32 v220, v220, v9, v8
    v_mul_u32_u24 v220, 1152, v220
    v_add_u32 v23, v220, v7
    v_add_u32 v222, 512, v0
    v_mul_u32_u24 v6, 1821, v222
    v_lshrrev_b32 v6, 14, v6
    v_mul_u32_u24 v7, 9, v6
    v_sub_u32 v7, v222, v7
    v_lshl_add_u32 v7, v7, 4, s75
    v_bfe_u32 v8, v6, 1, 2
    v_and_b32 v9, 1, v6
    v_lshl_or_b32 v8, v9, 2, v8
    v_lshrrev_b32 v9, 4, v6
    v_mul_u32_u24 v220, 18, v9
    v_and_b32 v9, 1, v9
    v_lshl_add_u32 v220, v9, 1, v220
    v_and_b32 v9, 8, v6
    v_add3_u32 v220, v220, v9, v8
    v_mul_u32_u24 v220, 1152, v220
    v_add_u32 v24, v220, v7
    v_add_u32 v222, 768, v0
    v_mul_u32_u24 v6, 1821, v222
    v_lshrrev_b32 v6, 14, v6
    v_mul_u32_u24 v7, 9, v6
    v_sub_u32 v7, v222, v7
    v_lshl_add_u32 v7, v7, 4, s75
    v_bfe_u32 v8, v6, 1, 2
    v_and_b32 v9, 1, v6
    v_lshl_or_b32 v8, v9, 2, v8
    v_lshrrev_b32 v9, 4, v6
    v_mul_u32_u24 v220, 18, v9
    v_and_b32 v9, 1, v9
    v_lshl_add_u32 v220, v9, 1, v220
    v_and_b32 v9, 8, v6
    v_add3_u32 v220, v220, v9, v8
    v_mul_u32_u24 v220, 1152, v220
    v_add_u32 v25, v220, v7
    v_add_u32 v222, 1024, v0
    v_mul_u32_u24 v6, 1821, v222
    v_lshrrev_b32 v6, 14, v6
    v_mul_u32_u24 v7, 9, v6
    v_sub_u32 v7, v222, v7
    v_lshl_add_u32 v7, v7, 4, s75
    v_bfe_u32 v8, v6, 1, 2
    v_and_b32 v9, 1, v6
    v_lshl_or_b32 v8, v9, 2, v8
    v_lshrrev_b32 v9, 4, v6
    v_mul_u32_u24 v220, 18, v9
    v_and_b32 v9, 1, v9
    v_lshl_add_u32 v220, v9, 1, v220
    v_and_b32 v9, 8, v6
    v_add3_u32 v220, v220, v9, v8
    v_mul_u32_u24 v220, 1152, v220
    v_add_u32 v26, v220, v7
    v_lshrrev_b32 v9, 3, v6
    v_mul_u32_u24 v220, 72, v9
    v_lshrrev_b32 v9, 1, v8
    v_mul_u32_u24 v221, 18, v9
    v_and_b32 v9, 1, v9
    v_xor_b32 v9, 1, v9
    v_lshl_add_u32 v221, v9, 4, v221
    v_and_b32 v9, 1, v8
    v_add3_u32 v220, v220, v221, v9
    v_subrev_u32 v220, 1152, v220
    v_mul_u32_u24 v220, 1152, v220
    v_add_u32 v220, v220, v7
    v_add_u32 v221, 497664, v26
    v_cmp_le_u32 vcc, 128, v6
    s_nop 1
    v_cndmask_b32 v32, v221, v220, vcc
    v_add_u32 v222, 1280, v0
    v_mul_u32_u24 v6, 1821, v222
    v_lshrrev_b32 v6, 14, v6
    v_mul_u32_u24 v7, 9, v6
    v_sub_u32 v7, v222, v7
    v_lshl_add_u32 v7, v7, 4, s75
    v_bfe_u32 v8, v6, 1, 2
    v_and_b32 v9, 1, v6
    v_lshl_or_b32 v8, v9, 2, v8
    v_lshrrev_b32 v9, 4, v6
    v_mul_u32_u24 v220, 18, v9
    v_and_b32 v9, 1, v9
    v_lshl_add_u32 v220, v9, 1, v220
    v_and_b32 v9, 8, v6
    v_add3_u32 v220, v220, v9, v8
    v_mul_u32_u24 v220, 1152, v220
    v_add_u32 v27, v220, v7
    v_lshrrev_b32 v9, 3, v6
    v_mul_u32_u24 v220, 72, v9
    v_lshrrev_b32 v9, 1, v8
    v_mul_u32_u24 v221, 18, v9
    v_and_b32 v9, 1, v9
    v_xor_b32 v9, 1, v9
    v_lshl_add_u32 v221, v9, 4, v221
    v_and_b32 v9, 1, v8
    v_add3_u32 v220, v220, v221, v9
    v_subrev_u32 v220, 1152, v220
    v_mul_u32_u24 v220, 1152, v220
    v_add_u32 v220, v220, v7
    v_add_u32 v221, 497664, v27
    v_cmp_le_u32 vcc, 128, v6
    s_nop 1
    v_cndmask_b32 v33, v221, v220, vcc
    s_movk_i32 s72, 1408
    s_cmp_lt_u32 s3, 2
    s_cselect_b32 s72, 1024, s72
    v_add_u32 v222, s72, v0
    v_mul_u32_u24 v6, 1821, v222
    v_lshrrev_b32 v6, 14, v6
    v_mul_u32_u24 v7, 9, v6
    v_sub_u32 v7, v222, v7
    v_lshl_add_u32 v7, v7, 4, s75
    v_bfe_u32 v8, v6, 1, 2
    v_and_b32 v9, 1, v6
    v_lshl_or_b32 v8, v9, 2, v8
    v_lshrrev_b32 v9, 4, v6
    v_mul_u32_u24 v220, 18, v9
    v_and_b32 v9, 1, v9
    v_lshl_add_u32 v220, v9, 1, v220
    v_and_b32 v9, 8, v6
    v_add3_u32 v220, v220, v9, v8
    v_mul_u32_u24 v220, 1152, v220
    v_add_u32 v28, v220, v7
    v_lshrrev_b32 v9, 3, v6
    v_mul_u32_u24 v220, 72, v9
    v_lshrrev_b32 v9, 1, v8
    v_mul_u32_u24 v221, 18, v9
    v_and_b32 v9, 1, v9
    v_xor_b32 v9, 1, v9
    v_lshl_add_u32 v221, v9, 4, v221
    v_and_b32 v9, 1, v8
    v_add3_u32 v220, v220, v221, v9
    v_subrev_u32 v220, 1152, v220
    v_mul_u32_u24 v220, 1152, v220
    v_add_u32 v220, v220, v7
    v_add_u32 v221, 497664, v28
    v_cmp_le_u32 vcc, 128, v6
    s_nop 1
    v_cndmask_b32 v34, v221, v220, vcc
    v_lshrrev_b32 v222, 2, v0
    v_add_u32 v222, 1664, v222
    v_mul_u32_u24 v6, 1821, v222
    v_lshrrev_b32 v6, 14, v6
    v_mul_u32_u24 v7, 9, v6
    v_sub_u32 v7, v222, v7
    v_lshl_add_u32 v7, v7, 4, s75
    v_bfe_u32 v8, v6, 1, 2
    v_and_b32 v9, 1, v6
    v_lshl_or_b32 v8, v9, 2, v8
    v_lshrrev_b32 v9, 4, v6
    v_mul_u32_u24 v220, 18, v9
    v_and_b32 v9, 1, v9
    v_lshl_add_u32 v220, v9, 1, v220
    v_and_b32 v9, 8, v6
    v_add3_u32 v220, v220, v9, v8
    v_mul_u32_u24 v220, 1152, v220
    v_add_u32 v29, v220, v7
    v_lshrrev_b32 v9, 3, v6
    v_mul_u32_u24 v220, 72, v9
    v_lshrrev_b32 v9, 1, v8
    v_mul_u32_u24 v221, 18, v9
    v_and_b32 v9, 1, v9
    v_xor_b32 v9, 1, v9
    v_lshl_add_u32 v221, v9, 4, v221
    v_and_b32 v9, 1, v8
    v_add3_u32 v220, v220, v221, v9
    v_subrev_u32 v220, 1152, v220
    v_mul_u32_u24 v220, 1152, v220
    v_add_u32 v220, v220, v7
    v_add_u32 v221, 497664, v29
    v_cmp_le_u32 vcc, 128, v6
    s_nop 1
    v_cndmask_b32 v35, v221, v220, vcc
    v_lshl_add_u32 v29, v5, 2, v29
    v_lshl_add_u32 v35, v5, 2, v35
    s_cmp_lt_u32 s3, 2
    s_cselect_b64 vcc, -1, 0
    v_cndmask_b32 v95, v34, v28, vcc
    s_nop 4
    s_branch .Lfbret
.section .rodata,"a"
.p2align 6
.amdhsa_kernel gated_mix__sliding_local_dilated__sliding_local_dilated__prompt_kernel
  .amdhsa_next_free_vgpr 512
  .amdhsa_next_free_sgpr 102
  .amdhsa_accum_offset 256
  .amdhsa_group_segment_fixed_size 0
  .amdhsa_kernarg_size 80
  .amdhsa_user_sgpr_count 2
  .amdhsa_user_sgpr_kernarg_segment_ptr 1
  .amdhsa_system_sgpr_workgroup_id_x 1
  .amdhsa_float_denorm_mode_32 3
  .amdhsa_float_denorm_mode_16_64 3
.end_amdhsa_kernel
```
